```python
import torch

def _softmax(x, axis=-1):
    return torch.softmax(x, dim=axis)
def _gelu(x):
    return torch.nn.functional.gelu(x, approximate="tanh")
def _silu(x):
    return torch.nn.functional.silu(x)
def _sigmoid(x):
    return torch.sigmoid(x)
def _layernorm(x, axis=-1, eps=1e-5):
    m = x.mean(dim=axis, keepdim=True)
    v = x.var(dim=axis, keepdim=True, unbiased=False)
    return (x - m) / torch.sqrt(v + eps)
def _scatter_add(tgt, idx, src, axis=0):
    return tgt.clone().index_add_(axis, idx, src)
def _segment_sum(src, seg, n):
    out = torch.zeros((n,) + src.shape[1:], dtype=src.dtype)
    return out.index_add_(0, seg, src)
def _pad(x, pw):
    flat = tuple(v for pair in reversed(pw) for v in pair)
    return torch.nn.functional.pad(x, flat)

kernel_name = 'parallel_sum__ssm_conv_s4__dense_activation_silu__prompt'

def setup_inputs():

    _w = (lambda a: (lambda t: t.to(torch.bfloat16) if t.is_floating_point() else t)(torch.as_tensor(a)))
    def _A_setup():
        B, L, D, N = 1, 2048, 512, 128
        A_re = -(lambda _x: torch.exp(torch.as_tensor(_x)))((lambda *s: torch.randn(*s, dtype=torch.bfloat16) * 6.4)(D, N))
        A_im = torch.pi * (lambda *s: torch.randn(*s, dtype=torch.bfloat16) * 0.05)(D, N)
        B_re = (lambda *s: torch.randn(*s, dtype=torch.bfloat16) * 0.1)(D, N)
        B_im = (lambda *s: torch.randn(*s, dtype=torch.bfloat16) * 0.1)(D, N)
        C_re = (lambda *s: torch.randn(*s, dtype=torch.bfloat16) * 0.1)(D, N)
        C_im = (lambda *s: torch.randn(*s, dtype=torch.bfloat16) * 0.1)(D, N)
        log_dt = (lambda *s: torch.randn(*s, dtype=torch.bfloat16) * 0.05)(D) * 0.5 - 4.0
        Dskip = (lambda *s: torch.randn(*s, dtype=torch.bfloat16) * 0.05)(D)
        return {
            "u": _w((lambda *s: torch.randn(*s, dtype=torch.bfloat16) * 0.05)(B, L, D)),
            "A_re": _w(A_re),
            "A_im": _w(A_im),
            "B_re": _w(B_re),
            "B_im": _w(B_im),
            "C_re": _w(C_re),
            "C_im": _w(C_im),
            "log_dt": _w(log_dt),
            "Dskip": _w(Dskip),
        }
    _A_in = _A_setup()

    def _B_setup():
        B, S, D, F = 1, 2048, 512, 1376
        return {
            "x": _w((lambda *s: torch.randn(*s, dtype=torch.bfloat16) * 0.05)(B, S, D)),
            "w1": _w((lambda *s: torch.randn(*s, dtype=torch.bfloat16) * 0.8)(D, F) * (D ** -0.5)),
            "w2": _w((lambda *s: torch.randn(*s, dtype=torch.bfloat16) * 0.2)(F, D) * (F ** -0.5)),
        }
    _B_in = _B_setup()

    return {
        "A_u": _A_in["u"],
        "A_A_re": _A_in["A_re"],
        "A_A_im": _A_in["A_im"],
        "A_B_re": _A_in["B_re"],
        "A_B_im": _A_in["B_im"],
        "A_C_re": _A_in["C_re"],
        "A_C_im": _A_in["C_im"],
        "A_log_dt": _A_in["log_dt"],
        "A_Dskip": _A_in["Dskip"],
        "B_x": _B_in["x"],
        "B_w1": _B_in["w1"],
        "B_w2": _B_in["w2"],
    }

def reference(A_u, A_A_re, A_A_im, A_B_re, A_B_im, A_C_re, A_C_im, A_log_dt, A_Dskip, B_x, B_w1, B_w2):
    def _A_ref(u, A_re, A_im, B_re, B_im, C_re, C_im, log_dt, Dskip):
        Bsz, L, D = u.shape
        dt = torch.exp(log_dt)[:, None]
        A = A_re + 1j * A_im
        Bc = B_re + 1j * B_im
        Cc = C_re + 1j * C_im
        logdA = dt * A
        dB = dt * Bc
        l = (lambda x, dt: x.to(dt))(torch.arange(L), A_re.dtype)
        P = torch.exp(logdA[:, :, None] * l[None, None, :])
        K = torch.einsum("dn,dnl,dn->dl", Cc, P, dB).real
        L2 = 2 * L
        Kp = _pad(K, ((0, 0), (0, L)))
        up = (lambda x, *d: x.permute(*d))(u, 0, 2, 1)
        up = _pad(up, ((0, 0), (0, 0), (0, L)))
        Kf = (lambda x, axes=(-2,-1): torch.fft.rfft2(x.float(), dim=axes))(Kp[:, None, :], axes=(-2, -1))
        Uf = (lambda x, axes=(-2,-1): torch.fft.rfft2(x.float(), dim=axes))(up[:, :, None, :], axes=(-2, -1))
        Yf = Uf * Kf[None, :, :, :]
        y = (lambda x, s, axes=(-2,-1): torch.fft.irfft2(x, s=s, dim=axes).to(torch.bfloat16))(Yf, (1, L2), axes=(-2, -1))[:, :, 0, :L]
        y = (lambda x, *d: x.permute(*d))(y, 0, 2, 1) + u * Dskip[None, None, :]
        return y

    def _B_ref(x, w1, w2):
        h = torch.einsum("bsd,df->bsf", x, w1)
        h = _silu(h)
        out = torch.einsum("bsf,fd->bsd", h, w2)
        return out

    x = A_u
    xn = _layernorm(x, axis=-1)
    return x + _A_ref(xn, A_A_re, A_A_im, A_B_re, A_B_im, A_C_re, A_C_im, A_log_dt, A_Dskip) + _B_ref(xn, B_w1, B_w2)
```

```asm
; @launch grid=(256,1,1) block=(512,1,1) lds=163840
.amdgcn_target "amdgcn-amd-amdhsa--gfx950"
.text
.globl parallel_sum__ssm_conv_s4__dense_activation_silu__prompt_kernel
.p2align 8
.type parallel_sum__ssm_conv_s4__dense_activation_silu__prompt_kernel,@function
parallel_sum__ssm_conv_s4__dense_activation_silu__prompt_kernel:
    s_cmp_ge_u32 s2, 256
    s_cbranch_scc1 L_end
    s_load_dwordx16 s[16:31], s[0:1], 0
    s_load_dwordx2 s[32:33], s[0:1], 64
    s_load_dwordx4 s[36:39], s[0:1], 80
    s_load_dwordx2 s[40:41], s[0:1], 96
    s_load_dwordx2 s[42:43], s[0:1], 112
    v_lshrrev_b32 v1, 6, v0
    v_and_b32 v0, 63, v0
    v_readfirstlane_b32 s12, v1
    v_mov_b32 v27, 0
    v_lshlrev_b32 v1, 2, v0
    v_add_u32 v1, 0x10000, v1
    ds_write_b32 v1, v27 offset:64512
    s_and_b32 s10, s2, 7
    s_lshr_b32 s11, s2, 3
    s_and_b32 s14, s11, 3
    s_lshr_b32 s8, s11, 2
    s_lshl_b32 s6, s10, 5
    s_add_u32 s6, s6, s11
    s_and_b32 s3, s12, 3
    s_mov_b32 s13, 0xffff0000
    s_mov_b32 s46, 14385152
    s_mov_b32 s47, 0x20000
    v_mov_b32 v31, 1
    v_lshlrev_b32 v26, 4, v0
    s_cmp_ge_u32 s12, 4
    s_cbranch_scc0 L_F
    s_setprio 3
    s_lshl_b32 s34, s6, 2
    s_lshl_b32 s56, s6, 9
    s_lshl_b32 s11, s3, 7
    s_add_u32 s56, s56, s11
    v_lshlrev_b32 v18, 1, v0
    v_add_u32 v18, s56, v18
    s_getpc_b64 s[52:53]
L_pc:
    s_sub_u32 s52, s52, L_pc-parallel_sum__ssm_conv_s4__dense_activation_silu__prompt_kernel
    s_subb_u32 s53, s53, 0
    s_bfe_u32 s10, s2, 0x30003
    s_lshl_b32 s10, s10, 2
    s_add_u32 s10, s10, s3
    s_mul_i32 s10, s10, 1024
    v_min_u32 v19, 7, v0
    v_lshlrev_b32 v19, 7, v19
    v_add_u32 v19, s10, v19
    v_min_u32 v19, L_end-parallel_sum__ssm_conv_s4__dense_activation_silu__prompt_kernel, v19
    global_load_dword v19, v19, s[52:53]
    s_waitcnt lgkmcnt(0)
    global_load_ushort v12, v18, s[18:19]
    global_load_ushort v13, v18, s[20:21]
    global_load_ushort v14, v18, s[22:23]
    global_load_ushort v15, v18, s[24:25]
    global_load_ushort v16, v18, s[26:27]
    global_load_ushort v17, v18, s[28:29]
    s_load_dword s35, s[30:31], s34
    s_load_dword s34, s[32:33], s34
    s_barrier
    s_branch L_S
L_F:
    s_setprio 3
    s_and_b32 s4, s10, 3
    s_lshl_b32 s4, s4, 2
    s_add_u32 s4, s4, s14
    s_lshr_b32 s5, s10, 2
    s_lshl_b32 s5, s5, 3
    s_add_u32 s5, s5, s8
    s_lshl_b32 s7, s10, 2
    s_add_u32 s7, s7, s14
    s_lshl_b32 s92, s4, 4
    s_add_u32 s92, s92, s5
    s_lshl_b32 s93, s92, 13
    s_lshl_b32 s11, s3, 8
    s_add_u32 s94, s93, s11
    v_lshrrev_b32 v5, 3, v0
    v_and_b32 v6, 7, v0
    v_lshlrev_b32 v24, 10, v5
    v_lshl_or_b32 v24, v6, 4, v24
    s_mov_b32 s50, 0x200000
    s_mov_b32 s51, 0x20000
    s_mov_b32 s54, 1409024
    s_mov_b32 s55, 0x20000
    v_and_b32 v7, 16, v0
    v_lshlrev_b32 v7, 2, v7
    v_xor_b32 v16, v7, v24
    v_add_u32 v17, 7152, v16
    v_add_u32 v18, 14304, v16
    v_add_u32 v19, 21456, v16
    s_lshl_b32 s95, s4, 2
    s_add_u32 s95, s95, s3
    s_add_u32 s35, s14, s8
    s_lshl_b32 s35, s35, 1
    s_and_b32 s7, s2, 3
    s_lshl_b32 s7, s7, 3
    s_bfe_u32 s11, s2, 0x30003
    s_add_u32 s7, s7, s11
    s_and_b32 s8, s2, 4
    s_lshr_b32 s11, s2, 6
    s_add_u32 s8, s8, s11
    s_getpc_b64 s[100:101]
    s_waitcnt lgkmcnt(0)
    s_mov_b32 s48, s16
    s_mov_b32 s49, s17
    buffer_load_dwordx4 v[160:163], v24, s[48:51], s94 offen
    buffer_load_dwordx4 v[164:167], v24, s[48:51], s94 offen offset:128
    s_mov_b32 s18, s95
    s_lshl_b32 s19, s18, 15
    s_mul_i32 s20, s3, 4160
    s_add_u32 s10, s35, 0
    s_and_b32 s10, s10, 7
    s_lshl_b32 s22, s10, 7
    s_add_u32 s22, s22, s19
    s_add_u32 m0, s20, 0
    s_mul_i32 s17, s10, 176128
    buffer_load_dwordx4 v16, s[48:51], s22 offen lds
    buffer_load_dwordx4 v17, s[48:51], s22 offen offset:1040 lds
    buffer_load_dwordx4 v18, s[48:51], s22 offen offset:2080 lds
    buffer_load_dwordx4 v19, s[48:51], s22 offen offset:3120 lds
    s_add_u32 s44, s42, 0
    s_addc_u32 s45, s43, 0
    s_load_dword s9, s[44:45], 0
    s_mov_b32 s52, s36
    s_mov_b32 s53, s37
    s_mul_i32 s15, s5, 3
    s_lshr_b32 s10, s5, 2
    s_sub_u32 s15, s15, s10
    s_and_b32 s10, s5, 3
    s_cmp_eq_u32 s10, 3
    s_cselect_b32 s34, 8, 12
    s_cmp_eq_u32 s5, 15
    s_cselect_b32 s34, 4, s34
    s_mov_b32 s5, s34
    v_mov_b32 v7, 0x40000000
    s_mul_i32 s16, s3, 44032
    s_lshl_b32 s10, s15, 6
    s_add_u32 s16, s16, s10
    s_mul_i32 s21, s3, 3072
    s_add_u32 s21, s21, 16640
    s_lshl_b32 s36, s3, 2
    s_add_u32 s36, s36, 130176
    v_add_u32 v4, 0, v0
    v_mul_u32_u24 v1, 5462, v4
    v_lshrrev_b32 v1, 16, v1
    v_mul_u32_u24 v2, 12, v1
    v_sub_u32 v2, v4, v2
    v_cmp_gt_u32 vcc, s34, v2
    v_mul_u32_u24 v1, 2752, v1
    v_lshl_add_u32 v1, v2, 4, v1
    v_cndmask_b32 v8, v7, v1, vcc
    v_add_u32 v4, 64, v0
    v_mul_u32_u24 v1, 5462, v4
    v_lshrrev_b32 v1, 16, v1
    v_mul_u32_u24 v2, 12, v1
    v_sub_u32 v2, v4, v2
    v_cmp_gt_u32 vcc, s34, v2
    v_mul_u32_u24 v1, 2752, v1
    v_lshl_add_u32 v1, v2, 4, v1
    v_cndmask_b32 v9, v7, v1, vcc
    v_subrev_u32 v9, 1024, v9
    v_add_u32 v4, 128, v0
    v_mul_u32_u24 v1, 5462, v4
    v_lshrrev_b32 v1, 16, v1
    v_mul_u32_u24 v2, 12, v1
    v_sub_u32 v2, v4, v2
    v_cmp_gt_u32 vcc, s34, v2
    v_mul_u32_u24 v1, 2752, v1
    v_lshl_add_u32 v1, v2, 4, v1
    v_cndmask_b32 v10, v7, v1, vcc
    v_subrev_u32 v10, 2048, v10
    s_add_u32 m0, s21, 0
    s_add_u32 s17, s17, s16
    buffer_load_dwordx4 v8, s[52:55], s17 offen lds
    buffer_load_dwordx4 v9, s[52:55], s17 offen offset:1024 lds
    buffer_load_dwordx4 v10, s[52:55], s17 offen offset:2048 lds
    s_barrier
    s_mov_b32 s34, m0
    s_add_u32 m0, s36, 0
    s_mov_b64 exec, 1
    global_load_lds_dword v27, s[100:101]
    s_mov_b64 exec, -1
    s_mov_b32 m0, s34
    s_add_u32 s10, s35, 1
    s_and_b32 s10, s10, 7
    s_lshl_b32 s22, s10, 7
    s_add_u32 s22, s22, s19
    s_add_u32 m0, s20, 28928
    s_mul_i32 s17, s10, 176128
    buffer_load_dwordx4 v16, s[48:51], s22 offen lds
    s_mov_b32 s56, s38
    s_mov_b32 s57, s39
    v_mov_b32 v30, 130176
    v_mov_b32 v43, 130048
    v_bfe_u32 v1, v0, 2, 2
    v_and_b32 v2, 3, v0
    v_lshrrev_b32 v3, 5, v0
    v_bfe_u32 v4, v0, 4, 1
    s_mov_b32 s33, 0x3f803f80
    v_mov_b32 v192, 0
    v_mov_b32 v193, 0
    v_lshlrev_b32 v201, 5, v5
    v_add_u32 v201, 129792, v201
    s_lshl_b32 s10, s3, 3
    v_add_u32 v202, s10, v201
    s_mul_i32 s10, s3, 4160
    s_add_u32 s10, s10, 87424
    v_mul_u32_u24 v203, 272, v5
    v_mul_u32_u24 v7, 15552, v3
    v_add_u32 v203, v203, v7
    v_lshl_add_u32 v203, v6, 4, v203
    v_add_u32 v203, s10, v203
    v_mul_u32_u24 v204, 272, v1
    v_lshrrev_b32 v7, 4, v0
    v_lshl_add_u32 v204, v7, 5, v204
    v_lshl_add_u32 v204, v2, 3, v204
    v_add_u32 v204, s10, v204
    s_lshl_b32 s10, s3, 11
    s_mul_i32 s37, s92, 8192
    s_add_u32 s37, s37, s10
    s_add_u32 s37, s37, 2621440
    s_lshl_b32 s38, s92, 7
    s_add_u32 s38, s38, 4096
    s_lshl_b32 s39, s92, 3
    s_add_u32 s39, s39, 262144
    s_cmp_eq_u32 s3, 0
    s_cselect_b32 s38, s38, 0x40000000
    s_cselect_b32 s39, s39, 0x40000000
    v_lshl_add_u32 v7, v3, 3, v1
    v_mul_u32_u24 v7, 192, v7
    v_lshl_add_u32 v7, v4, 5, v7
    v_lshl_add_u32 v7, v2, 3, v7
    v_bfe_u32 v11, v0, 3, 2
    v_mul_u32_u24 v11, 1040, v11
    v_lshl_add_u32 v11, v6, 7, v11
    v_add_u32 v11, s20, v11
    v_lshlrev_b32 v12, 1, v0
    v_and_b32 v12, 4, v12
    v_or_b32 v12, v12, v3
    s_xor_b32 s10, s3, 0
    s_mul_i32 s11, s10, 3072
    s_add_u32 s11, s11, 16640
    v_add_u32 v32, s11, v7
    s_lshl_b32 s10, s10, 1
    v_xor_b32 v13, s10, v12
    v_lshl_add_u32 v20, v13, 4, v11
    s_xor_b32 s10, s3, 1
    s_mul_i32 s11, s10, 3072
    s_add_u32 s11, s11, 16640
    v_add_u32 v33, s11, v7
    s_lshl_b32 s10, s10, 1
    v_xor_b32 v13, s10, v12
    v_lshl_add_u32 v21, v13, 4, v11
    s_xor_b32 s10, s3, 2
    s_mul_i32 s11, s10, 3072
    s_add_u32 s11, s11, 16640
    v_add_u32 v34, s11, v7
    s_lshl_b32 s10, s10, 1
    v_xor_b32 v13, s10, v12
    v_lshl_add_u32 v22, v13, 4, v11
    s_xor_b32 s10, s3, 3
    s_mul_i32 s11, s10, 3072
    s_add_u32 s11, s11, 16640
    v_add_u32 v35, s11, v7
    s_lshl_b32 s10, s10, 1
    v_xor_b32 v13, s10, v12
    v_lshl_add_u32 v23, v13, 4, v11
    v_xor_b32 v36, v4, v1
    v_and_b32 v36, 1, v36
    v_cmp_eq_u32 vcc, 0, v36
    v_mov_b32 v37, s33
    s_nop 0
    v_cndmask_b32 v36, 0, v37, vcc
    v_mov_b32 v37, v36
    v_mov_b32 v38, v36
    v_mov_b32 v39, v36
    s_waitcnt vmcnt(9)
    v_dot2c_f32_bf16 v192, s33, v160
    v_dot2c_f32_bf16 v193, v160, v160
    v_dot2c_f32_bf16 v192, s33, v161
    v_dot2c_f32_bf16 v193, v161, v161
    v_dot2c_f32_bf16 v192, s33, v162
    v_dot2c_f32_bf16 v193, v162, v162
    v_dot2c_f32_bf16 v192, s33, v163
    v_dot2c_f32_bf16 v193, v163, v163
    v_dot2c_f32_bf16 v192, s33, v164
    v_dot2c_f32_bf16 v193, v164, v164
    v_dot2c_f32_bf16 v192, s33, v165
    v_dot2c_f32_bf16 v193, v165, v165
    v_dot2c_f32_bf16 v192, s33, v166
    v_dot2c_f32_bf16 v193, v166, v166
    v_dot2c_f32_bf16 v192, s33, v167
    v_dot2c_f32_bf16 v193, v167, v167
    buffer_load_dwordx4 v17, s[48:51], s22 offen offset:1040 lds
    v_lshlrev_b32 v208, 16, v160
    v_and_b32 v209, s13, v160
    v_add_f32_dpp v192, v192, v192 quad_perm:[1,0,3,2] row_mask:0xf bank_mask:0xf
    v_add_f32_dpp v193, v193, v193 quad_perm:[1,0,3,2] row_mask:0xf bank_mask:0xf
    v_lshlrev_b32 v210, 16, v161
    v_and_b32 v211, s13, v161
    v_add_f32_dpp v192, v192, v192 quad_perm:[2,3,0,1] row_mask:0xf bank_mask:0xf
    v_add_f32_dpp v193, v193, v193 quad_perm:[2,3,0,1] row_mask:0xf bank_mask:0xf
    v_lshlrev_b32 v212, 16, v162
    v_and_b32 v213, s13, v162
    v_add_f32_dpp v192, v192, v192 row_half_mirror row_mask:0xf bank_mask:0xf
    v_add_f32_dpp v193, v193, v193 row_half_mirror row_mask:0xf bank_mask:0xf
    ds_write_b64 v202, v[192:193]
    s_mov_b64 exec, 1
    ds_add_u32 v43, v31 offset:8
    s_mov_b64 exec, -1
    buffer_load_dwordx4 v18, s[48:51], s22 offen offset:2080 lds
    v_lshlrev_b32 v214, 16, v163
    v_and_b32 v215, s13, v163
    v_lshlrev_b32 v216, 16, v164
    v_and_b32 v217, s13, v164
    v_lshlrev_b32 v218, 16, v165
    v_and_b32 v219, s13, v165
    v_lshlrev_b32 v220, 16, v166
    v_and_b32 v221, s13, v166
    v_lshlrev_b32 v222, 16, v167
    v_and_b32 v223, s13, v167
    buffer_load_dwordx4 v19, s[48:51], s22 offen offset:3120 lds
    ds_read_b32 v11, v43 offset:8
    s_waitcnt lgkmcnt(0)
    v_readfirstlane_b32 s10, v11
    s_nop 0
    s_cmp_ge_u32 s10, 4
    s_cbranch_scc0 LW_1
LW_2:
    ds_read_b128 v[192:195], v201
    ds_read_b128 v[196:199], v201 offset:16
    s_mul_i32 s9, s9, 1664525
    s_add_u32 s9, s9, 1013904223
    v_mov_b32 v28, s9
    v_mov_b32 v29, 1
    ds_write_b64 v43, v[28:29] offset:48
    s_add_u32 m0, s21, 28928
    s_add_u32 s17, s17, s16
    buffer_load_dwordx4 v8, s[52:55], s17 offen lds
    buffer_load_dwordx4 v9, s[52:55], s17 offen offset:1024 lds
    s_waitcnt lgkmcnt(0)
    v_pk_add_f32 v[192:193], v[192:193], v[194:195]
    v_pk_add_f32 v[196:197], v[196:197], v[198:199]
    v_pk_add_f32 v[192:193], v[192:193], v[196:197]
    v_mul_f32 v192, 0x3b000000, v192
    v_mul_f32 v193, 0x3b000000, v193
    v_fma_f32 v193, -v192, v192, v193
    v_max_f32 v193, 0, v193
    v_cvt_pk_bf16_f32 v193, v193, v193
    v_and_b32 v193, s13, v193
    v_add_f32 v193, 0x3727c5ac, v193
    v_cvt_pk_bf16_f32 v193, v193, v193
    v_and_b32 v193, s13, v193
    v_sqrt_f32 v193, v193
    v_mov_b32 v195, s9
    s_mov_b32 exec_lo, 0x01010101
    s_mov_b32 exec_hi, 0x01010101
    v_cvt_pk_bf16_f32 v194, v192, v193
    buffer_store_dwordx2 v[194:195], v0, s[44:47], s38 offen sc1
    s_mov_b64 exec, -1
    v_cvt_pk_bf16_f32 v196, v192, v193
    v_and_b32 v193, s13, v196
    v_rcp_f32 v193, v193
    v_lshlrev_b32 v192, 16, v196
    v_mul_f32 v192, v192, v193
    buffer_load_dwordx4 v10, s[52:55], s17 offen offset:2048 lds
    v_pk_fma_f32 v[208:209], v[208:209], v[192:193], v[192:193] op_sel:[0,1,0] op_sel_hi:[1,1,0] neg_lo:[0,0,1] neg_hi:[0,0,1]
    v_pk_fma_f32 v[210:211], v[210:211], v[192:193], v[192:193] op_sel:[0,1,0] op_sel_hi:[1,1,0] neg_lo:[0,0,1] neg_hi:[0,0,1]
    v_pk_fma_f32 v[212:213], v[212:213], v[192:193], v[192:193] op_sel:[0,1,0] op_sel_hi:[1,1,0] neg_lo:[0,0,1] neg_hi:[0,0,1]
    v_pk_fma_f32 v[214:215], v[214:215], v[192:193], v[192:193] op_sel:[0,1,0] op_sel_hi:[1,1,0] neg_lo:[0,0,1] neg_hi:[0,0,1]
    v_pk_fma_f32 v[216:217], v[216:217], v[192:193], v[192:193] op_sel:[0,1,0] op_sel_hi:[1,1,0] neg_lo:[0,0,1] neg_hi:[0,0,1]
    v_pk_fma_f32 v[218:219], v[218:219], v[192:193], v[192:193] op_sel:[0,1,0] op_sel_hi:[1,1,0] neg_lo:[0,0,1] neg_hi:[0,0,1]
    v_pk_fma_f32 v[220:221], v[220:221], v[192:193], v[192:193] op_sel:[0,1,0] op_sel_hi:[1,1,0] neg_lo:[0,0,1] neg_hi:[0,0,1]
    v_pk_fma_f32 v[222:223], v[222:223], v[192:193], v[192:193] op_sel:[0,1,0] op_sel_hi:[1,1,0] neg_lo:[0,0,1] neg_hi:[0,0,1]
    v_cvt_pk_bf16_f32 v160, v208, v209
    v_cvt_pk_bf16_f32 v161, v210, v211
    v_cvt_pk_bf16_f32 v162, v212, v213
    v_cvt_pk_bf16_f32 v163, v214, v215
    ds_write_b128 v203, v[160:163]
    v_cvt_pk_bf16_f32 v164, v216, v217
    v_cvt_pk_bf16_f32 v165, v218, v219
    v_cvt_pk_bf16_f32 v166, v220, v221
    v_cvt_pk_bf16_f32 v167, v222, v223
    ds_write_b128 v203, v[164:167] offset:128
    ds_read_b64_tr_b16 v[184:185], v204
    ds_read_b64_tr_b16 v[186:187], v204 offset:16640
    ds_read_b64_tr_b16 v[188:189], v204 offset:128
    ds_read_b64_tr_b16 v[190:191], v204 offset:16768
    s_mov_b32 s34, m0
    s_add_u32 m0, s36, 16
    s_mov_b64 exec, 1
    global_load_lds_dword v27, s[100:101]
    s_mov_b64 exec, -1
    s_mov_b32 m0, s34
    s_add_u32 s10, s35, 2
    s_and_b32 s10, s10, 7
    s_lshl_b32 s22, s10, 7
    s_add_u32 s22, s22, s19
    s_add_u32 m0, s20, 57856
    s_mul_i32 s17, s10, 176128
    buffer_load_dwordx4 v16, s[48:51], s22 offen lds
    s_waitcnt lgkmcnt(2)
    buffer_store_dwordx4 v[184:187], v26, s[44:47], s37 offen sc1
    s_waitcnt lgkmcnt(0)
    buffer_store_dwordx4 v[188:191], v26, s[44:47], s37 offen offset:1024 sc1
    s_setprio 2
    buffer_load_dwordx4 v17, s[48:51], s22 offen offset:1040 lds
    ds_read_b128 v[156:159], v30 offset:0
    s_waitcnt lgkmcnt(0)
    v_min3_u32 v156, v156, v157, v158
    v_min_u32 v156, v156, v159
    s_nop 0
    v_readfirstlane_b32 s10, v156
    s_nop 0
    s_cmp_lg_u32 s10, 0
    s_cbranch_scc0 LC_3
LC_4:
    ds_read_b128 v[128:131], v20
    ds_read_b64_tr_b16 v[44:45], v32 offset:0
    ds_read_b64_tr_b16 v[46:47], v32 offset:768
    ds_read_b64_tr_b16 v[48:49], v32 offset:64
    ds_read_b64_tr_b16 v[50:51], v32 offset:832
    ds_read_b64_tr_b16 v[52:53], v32 offset:128
    ds_read_b64_tr_b16 v[54:55], v32 offset:896
    ds_read_b128 v[132:135], v21
    ds_read_b64_tr_b16 v[56:57], v33 offset:0
    ds_read_b64_tr_b16 v[58:59], v33 offset:768
    ds_read_b64_tr_b16 v[60:61], v33 offset:64
    ds_read_b64_tr_b16 v[62:63], v33 offset:832
    ds_read_b64_tr_b16 v[64:65], v33 offset:128
    ds_read_b64_tr_b16 v[66:67], v33 offset:896
    s_waitcnt lgkmcnt(7)
    v_mfma_f32_32x32x16_bf16 v[80:95], v[44:47], v[128:131], 0
    ds_read_b128 v[136:139], v22
    ds_read_b64_tr_b16 v[68:69], v34 offset:0
    ds_read_b64_tr_b16 v[70:71], v34 offset:768
    v_mfma_f32_32x32x16_bf16 v[96:111], v[48:51], v[128:131], 0
    ds_read_b64_tr_b16 v[72:73], v34 offset:64
    ds_read_b64_tr_b16 v[74:75], v34 offset:832
    ds_read_b64_tr_b16 v[76:77], v34 offset:128
    buffer_load_dwordx4 v18, s[48:51], s22 offen offset:2080 lds
    v_mfma_f32_32x32x16_bf16 v[112:127], v[52:55], v[128:131], 0
    ds_read_b64_tr_b16 v[78:79], v34 offset:896
    v_mfma_f32_16x16x32_bf16 v[140:143], v[36:39], v[44:47], 0
    buffer_load_dwordx4 v19, s[48:51], s22 offen offset:3120 lds
    v_mfma_f32_16x16x32_bf16 v[144:147], v[36:39], v[48:51], 0
    v_mfma_f32_16x16x32_bf16 v[148:151], v[36:39], v[52:55], 0
    s_waitcnt lgkmcnt(7)
    v_mfma_f32_32x32x16_bf16 v[80:95], v[56:59], v[132:135], v[80:95]
    ds_read_b128 v[128:131], v23
    ds_read_b64_tr_b16 v[44:45], v35 offset:0
    ds_read_b64_tr_b16 v[46:47], v35 offset:768
    s_add_u32 m0, s21, 57856
    s_add_u32 s17, s17, s16
    buffer_load_dwordx4 v8, s[52:55], s17 offen lds
    v_mfma_f32_32x32x16_bf16 v[96:111], v[60:63], v[132:135], v[96:111]
    ds_read_b64_tr_b16 v[48:49], v35 offset:64
    ds_read_b64_tr_b16 v[50:51], v35 offset:832
    ds_read_b64_tr_b16 v[52:53], v35 offset:128
    v_mfma_f32_32x32x16_bf16 v[112:127], v[64:67], v[132:135], v[112:127]
    ds_read_b64_tr_b16 v[54:55], v35 offset:896
    buffer_load_dwordx4 v9, s[52:55], s17 offen offset:1024 lds
    ds_read_b128 v[156:159], v30 offset:16
    s_waitcnt lgkmcnt(8)
    v_mfma_f32_32x32x16_bf16 v[80:95], v[68:71], v[136:139], v[80:95]
    buffer_load_dwordx4 v10, s[52:55], s17 offen offset:2048 lds
    v_mfma_f32_32x32x16_bf16 v[96:111], v[72:75], v[136:139], v[96:111]
    s_mov_b32 s58, 1409024
    s_mov_b32 s59, 0x20000
    s_mov_b32 s60, s40
    s_mov_b32 s61, s41
    s_mov_b32 s62, 0x200000
    s_mov_b32 s63, 0x20000
    v_add_u32 v25, 7168, v16
    v_lshl_add_u32 v7, v3, 2, v1
    v_lshlrev_b32 v7, 7, v7
    v_lshl_add_u32 v7, v4, 5, v7
    v_lshl_add_u32 v7, v2, 3, v7
    v_lshrrev_b32 v11, 1, v1
    v_lshl_add_u32 v7, v11, 6, v7
    v_xor_b32 v11, 64, v7
    s_mul_i32 s23, s3, 7168
    s_mul_i32 s24, s3, 8320
    s_add_u32 s24, s24, 130304
    v_add_u32 v12, s23, v7
    v_add_u32 v13, s23, v11
    v_add_u32 v14, s24, v7
    v_add_u32 v15, s24, v11
    s_mul_i32 s25, s3, 360448
    s_lshl_b32 s10, s8, 7
    s_add_u32 s25, s25, s10
    s_sub_u32 s25, s25, 16384
    s_mul_i32 s28, s3, 1802240
    s_mul_i32 s10, s7, 5120
    s_add_u32 s28, s28, s10
    s_add_u32 s28, s28, 7176192
    s_mul_i32 s26, s15, 163840
    s_lshr_b32 s10, s18, 1
    s_mul_i32 s10, s10, 5120
    s_add_u32 s26, s26, s10
    s_and_b32 s10, s3, 1
    s_lshl_b32 s11, s10, 11
    s_add_u32 s26, s26, s11
    s_add_u32 s26, s26, 7340032
    s_mov_b32 s41, 0
    s_mul_i32 s10, s10, 1792
    s_sub_u32 s94, s26, s10
    s_add_u32 s94, s94, 4096
    s_mov_b32 s40, s25
    s_add_u32 s40, s40, 212992
    s_lshl_b32 s10, s3, 2
    s_add_u32 s10, s10, 6144
    v_and_b32 v41, 31, v0
    v_lshlrev_b32 v41, 4, v41
    v_add_u32 v41, s10, v41
    v_and_b32 v42, 31, v0
    v_lshrrev_b32 v40, 3, v42
    v_lshlrev_b32 v40, 7, v40
    v_lshl_or_b32 v40, v6, 3, v40
    v_lshlrev_b32 v42, 4, v42
    v_add_u32 v42, 6144, v42
    s_lshl_b32 s27, s18, 9
    s_add_u32 s27, s27, 4096
    ds_read_b128 v[156:159], v30 offset:16
    s_waitcnt lgkmcnt(0)
    v_min3_u32 v156, v156, v157, v158
    v_min_u32 v156, v156, v159
    s_nop 0
    v_readfirstlane_b32 s10, v156
    s_nop 0
    s_cmp_lg_u32 s10, 0
    s_cbranch_scc0 LC_5
LC_6:
    s_waitcnt vmcnt(6)
    s_mov_b32 s34, m0
    s_add_u32 m0, s36, 32
    s_mov_b64 exec, 1
    global_load_lds_dword v27, s[100:101]
    s_mov_b64 exec, -1
    s_mov_b32 m0, s34
    v_add_u32 v20, 0x7100, v20
    v_add_u32 v32, 0x7100, v32
    ds_read_b128 v[132:135], v20
    ds_read_b64_tr_b16 v[56:57], v32 offset:0
    v_mfma_f32_32x32x16_bf16 v[112:127], v[76:79], v[136:139], v[112:127]
    ds_read_b64_tr_b16 v[58:59], v32 offset:768
    ds_read_b64_tr_b16 v[60:61], v32 offset:64
    ds_read_b64_tr_b16 v[62:63], v32 offset:832
    ds_read_b64_tr_b16 v[64:65], v32 offset:128
    ds_read_b64_tr_b16 v[66:67], v32 offset:896
    s_waitcnt lgkmcnt(7)
    v_mfma_f32_32x32x16_bf16 v[80:95], v[44:47], v[128:131], v[80:95]
    v_add_u32 v21, 0x7100, v21
    v_add_u32 v33, 0x7100, v33
    ds_read_b128 v[136:139], v21
    ds_read_b64_tr_b16 v[68:69], v33 offset:0
    s_add_u32 s10, s35, 3
    s_and_b32 s10, s10, 7
    s_lshl_b32 s22, s10, 7
    s_add_u32 s22, s22, s19
    s_add_u32 m0, s20, 130304
    s_mul_i32 s17, s10, 176128
    buffer_load_dwordx4 v16, s[48:51], s22 offen lds
    v_mfma_f32_32x32x16_bf16 v[96:111], v[48:51], v[128:131], v[96:111]
    ds_read_b64_tr_b16 v[70:71], v33 offset:768
    ds_read_b64_tr_b16 v[72:73], v33 offset:64
    ds_read_b64_tr_b16 v[74:75], v33 offset:832
    v_mfma_f32_32x32x16_bf16 v[112:127], v[52:55], v[128:131], v[112:127]
    ds_read_b64_tr_b16 v[76:77], v33 offset:128
    ds_read_b64_tr_b16 v[78:79], v33 offset:896
    buffer_load_dwordx4 v17, s[48:51], s22 offen offset:1040 lds
    s_waitcnt lgkmcnt(7)
    v_mfma_f32_32x32x16_bf16 v[80:95], v[56:59], v[132:135], v[80:95]
    v_add_u32 v22, 0x7100, v22
    v_add_u32 v34, 0x7100, v34
    ds_read_b128 v[128:131], v22
    ds_read_b64_tr_b16 v[44:45], v34 offset:0
    v_mfma_f32_32x32x16_bf16 v[96:111], v[60:63], v[132:135], v[96:111]
    ds_read_b64_tr_b16 v[46:47], v34 offset:768
    ds_read_b64_tr_b16 v[48:49], v34 offset:64
    ds_read_b64_tr_b16 v[50:51], v34 offset:832
    buffer_load_dwordx4 v18, s[48:51], s22 offen offset:2080 lds
    v_mfma_f32_32x32x16_bf16 v[112:127], v[64:67], v[132:135], v[112:127]
    ds_read_b64_tr_b16 v[52:53], v34 offset:128
    ds_read_b64_tr_b16 v[54:55], v34 offset:896
    v_mfma_f32_16x16x32_bf16 v[140:143], v[36:39], v[56:59], v[140:143]
    buffer_load_dwordx4 v19, s[48:51], s22 offen offset:3120 lds
    v_mfma_f32_16x16x32_bf16 v[144:147], v[36:39], v[60:63], v[144:147]
    v_mfma_f32_16x16x32_bf16 v[148:151], v[36:39], v[64:67], v[148:151]
    s_waitcnt lgkmcnt(7)
    v_mfma_f32_32x32x16_bf16 v[80:95], v[68:71], v[136:139], v[80:95]
    v_add_u32 v23, 0x7100, v23
    v_add_u32 v35, 0x7100, v35
    ds_read_b128 v[132:135], v23
    ds_read_b64_tr_b16 v[56:57], v35 offset:0
    s_add_u32 m0, s21, 130304
    s_add_u32 s17, s17, s16
    buffer_load_dwordx4 v8, s[52:55], s17 offen lds
    v_mfma_f32_32x32x16_bf16 v[96:111], v[72:75], v[136:139], v[96:111]
    ds_read_b64_tr_b16 v[58:59], v35 offset:768
    ds_read_b64_tr_b16 v[60:61], v35 offset:64
    ds_read_b64_tr_b16 v[62:63], v35 offset:832
    v_mfma_f32_32x32x16_bf16 v[112:127], v[76:79], v[136:139], v[112:127]
    ds_read_b64_tr_b16 v[64:65], v35 offset:128
    ds_read_b64_tr_b16 v[66:67], v35 offset:896
    buffer_load_dwordx4 v9, s[52:55], s17 offen offset:1024 lds
    ds_read_b128 v[156:159], v30 offset:32
    s_waitcnt lgkmcnt(8)
    v_mfma_f32_32x32x16_bf16 v[80:95], v[44:47], v[128:131], v[80:95]
    buffer_load_dwordx4 v10, s[52:55], s17 offen offset:2048 lds
    v_mfma_f32_32x32x16_bf16 v[96:111], v[48:51], v[128:131], v[96:111]
    s_waitcnt lgkmcnt(0)
    v_min3_u32 v156, v156, v157, v158
    v_min_u32 v156, v156, v159
    s_nop 0
    v_readfirstlane_b32 s10, v156
    s_nop 0
    s_cmp_lg_u32 s10, 0
    s_cbranch_scc0 LC_7
LC_8:
    s_mov_b32 s34, m0
    s_add_u32 m0, s36, 48
    s_mov_b64 exec, 1
    global_load_lds_dword v27, s[100:101]
    s_mov_b64 exec, -1
    s_mov_b32 m0, s34
    s_mov_b64 exec, 1
    buffer_store_dword v28, v27, s[44:47], s39 offen sc1
    s_mov_b64 exec, -1
    v_add_u32 v20, 0x7100, v20
    v_add_u32 v32, 0x7100, v32
    ds_read_b128 v[136:139], v20
    ds_read_b64_tr_b16 v[68:69], v32 offset:0
    v_mfma_f32_32x32x16_bf16 v[112:127], v[52:55], v[128:131], v[112:127]
    ds_read_b64_tr_b16 v[70:71], v32 offset:768
    ds_read_b64_tr_b16 v[72:73], v32 offset:64
    ds_read_b64_tr_b16 v[74:75], v32 offset:832
    ds_read_b64_tr_b16 v[76:77], v32 offset:128
    ds_read_b64_tr_b16 v[78:79], v32 offset:896
    s_waitcnt lgkmcnt(7)
    v_mfma_f32_32x32x16_bf16 v[80:95], v[56:59], v[132:135], v[80:95]
    v_add_u32 v21, 0x7100, v21
    v_add_u32 v33, 0x7100, v33
    ds_read_b128 v[128:131], v21
    ds_read_b64_tr_b16 v[44:45], v33 offset:0
    s_add_u32 s10, s35, 4
    s_and_b32 s10, s10, 7
    s_lshl_b32 s22, s10, 7
    s_add_u32 s22, s22, s19
    s_add_u32 m0, s20, 0
    s_mul_i32 s17, s10, 176128
    buffer_load_dwordx4 v16, s[48:51], s22 offen lds
    v_mfma_f32_32x32x16_bf16 v[96:111], v[60:63], v[132:135], v[96:111]
    ds_read_b64_tr_b16 v[46:47], v33 offset:768
    ds_read_b64_tr_b16 v[48:49], v33 offset:64
    ds_read_b64_tr_b16 v[50:51], v33 offset:832
    v_mfma_f32_32x32x16_bf16 v[112:127], v[64:67], v[132:135], v[112:127]
    ds_read_b64_tr_b16 v[52:53], v33 offset:128
    ds_read_b64_tr_b16 v[54:55], v33 offset:896
    buffer_load_dwordx4 v17, s[48:51], s22 offen offset:1040 lds
    s_waitcnt lgkmcnt(7)
    v_mfma_f32_32x32x16_bf16 v[80:95], v[68:71], v[136:139], v[80:95]
    v_add_u32 v22, 0x7100, v22
    v_add_u32 v34, 0x7100, v34
    ds_read_b128 v[132:135], v22
    ds_read_b64_tr_b16 v[56:57], v34 offset:0
    v_mfma_f32_32x32x16_bf16 v[96:111], v[72:75], v[136:139], v[96:111]
    ds_read_b64_tr_b16 v[58:59], v34 offset:768
    ds_read_b64_tr_b16 v[60:61], v34 offset:64
    ds_read_b64_tr_b16 v[62:63], v34 offset:832
    buffer_load_dwordx4 v18, s[48:51], s22 offen offset:2080 lds
    v_mfma_f32_32x32x16_bf16 v[112:127], v[76:79], v[136:139], v[112:127]
    ds_read_b64_tr_b16 v[64:65], v34 offset:128
    ds_read_b64_tr_b16 v[66:67], v34 offset:896
    v_mfma_f32_16x16x32_bf16 v[140:143], v[36:39], v[68:71], v[140:143]
    buffer_load_dwordx4 v19, s[48:51], s22 offen offset:3120 lds
    v_mfma_f32_16x16x32_bf16 v[144:147], v[36:39], v[72:75], v[144:147]
    v_mfma_f32_16x16x32_bf16 v[148:151], v[36:39], v[76:79], v[148:151]
    s_waitcnt lgkmcnt(7)
    v_mfma_f32_32x32x16_bf16 v[80:95], v[44:47], v[128:131], v[80:95]
    v_add_u32 v23, 0x7100, v23
    v_add_u32 v35, 0x7100, v35
    ds_read_b128 v[136:139], v23
    ds_read_b64_tr_b16 v[68:69], v35 offset:0
    s_add_u32 m0, s21, 0
    s_add_u32 s17, s17, s16
    buffer_load_dwordx4 v8, s[52:55], s17 offen lds
    v_mfma_f32_32x32x16_bf16 v[96:111], v[48:51], v[128:131], v[96:111]
    ds_read_b64_tr_b16 v[70:71], v35 offset:768
    ds_read_b64_tr_b16 v[72:73], v35 offset:64
    ds_read_b64_tr_b16 v[74:75], v35 offset:832
    v_mfma_f32_32x32x16_bf16 v[112:127], v[52:55], v[128:131], v[112:127]
    ds_read_b64_tr_b16 v[76:77], v35 offset:128
    ds_read_b64_tr_b16 v[78:79], v35 offset:896
    buffer_load_dwordx4 v9, s[52:55], s17 offen offset:1024 lds
    ds_read_b128 v[156:159], v30 offset:48
    s_waitcnt lgkmcnt(8)
    v_mfma_f32_32x32x16_bf16 v[80:95], v[56:59], v[132:135], v[80:95]
    buffer_load_dwordx4 v10, s[52:55], s17 offen offset:2048 lds
    v_mfma_f32_32x32x16_bf16 v[96:111], v[60:63], v[132:135], v[96:111]
    s_waitcnt lgkmcnt(0)
    v_min3_u32 v156, v156, v157, v158
    v_min_u32 v156, v156, v159
    s_nop 0
    v_readfirstlane_b32 s10, v156
    s_nop 0
    s_cmp_lg_u32 s10, 0
    s_cbranch_scc0 LC_9
LC_10:
    s_mov_b32 s34, m0
    s_add_u32 m0, s36, 64
    s_mov_b64 exec, 1
    global_load_lds_dword v27, s[100:101]
    s_mov_b64 exec, -1
    s_mov_b32 m0, s34
    v_add_u32 v20, 0x11b00, v20
    v_add_u32 v32, 0x11b00, v32
    ds_read_b128 v[128:131], v20
    ds_read_b64_tr_b16 v[44:45], v32 offset:0
    v_mfma_f32_32x32x16_bf16 v[112:127], v[64:67], v[132:135], v[112:127]
    ds_read_b64_tr_b16 v[46:47], v32 offset:768
    ds_read_b64_tr_b16 v[48:49], v32 offset:64
    ds_read_b64_tr_b16 v[50:51], v32 offset:832
    ds_read_b64_tr_b16 v[52:53], v32 offset:128
    ds_read_b64_tr_b16 v[54:55], v32 offset:896
    s_waitcnt lgkmcnt(7)
    v_mfma_f32_32x32x16_bf16 v[80:95], v[68:71], v[136:139], v[80:95]
    v_add_u32 v21, 0x11b00, v21
    v_add_u32 v33, 0x11b00, v33
    ds_read_b128 v[132:135], v21
    ds_read_b64_tr_b16 v[56:57], v33 offset:0
    s_add_u32 s10, s35, 5
    s_and_b32 s10, s10, 7
    s_lshl_b32 s22, s10, 7
    s_add_u32 s22, s22, s19
    s_add_u32 m0, s20, 28928
    s_mul_i32 s17, s10, 176128
    buffer_load_dwordx4 v16, s[48:51], s22 offen lds
    v_mfma_f32_32x32x16_bf16 v[96:111], v[72:75], v[136:139], v[96:111]
    ds_read_b64_tr_b16 v[58:59], v33 offset:768
    ds_read_b64_tr_b16 v[60:61], v33 offset:64
    ds_read_b64_tr_b16 v[62:63], v33 offset:832
    v_mfma_f32_32x32x16_bf16 v[112:127], v[76:79], v[136:139], v[112:127]
    ds_read_b64_tr_b16 v[64:65], v33 offset:128
    ds_read_b64_tr_b16 v[66:67], v33 offset:896
    buffer_load_dwordx4 v17, s[48:51], s22 offen offset:1040 lds
    s_waitcnt lgkmcnt(7)
    v_mfma_f32_32x32x16_bf16 v[80:95], v[44:47], v[128:131], v[80:95]
    v_add_u32 v22, 0x11b00, v22
    v_add_u32 v34, 0x11b00, v34
    ds_read_b128 v[136:139], v22
    ds_read_b64_tr_b16 v[68:69], v34 offset:0
    v_mfma_f32_32x32x16_bf16 v[96:111], v[48:51], v[128:131], v[96:111]
    ds_read_b64_tr_b16 v[70:71], v34 offset:768
    ds_read_b64_tr_b16 v[72:73], v34 offset:64
    ds_read_b64_tr_b16 v[74:75], v34 offset:832
    buffer_load_dwordx4 v18, s[48:51], s22 offen offset:2080 lds
    v_mfma_f32_32x32x16_bf16 v[112:127], v[52:55], v[128:131], v[112:127]
    ds_read_b64_tr_b16 v[76:77], v34 offset:128
    ds_read_b64_tr_b16 v[78:79], v34 offset:896
    v_mfma_f32_16x16x32_bf16 v[140:143], v[36:39], v[44:47], v[140:143]
    buffer_load_dwordx4 v19, s[48:51], s22 offen offset:3120 lds
    v_mfma_f32_16x16x32_bf16 v[144:147], v[36:39], v[48:51], v[144:147]
    v_mfma_f32_16x16x32_bf16 v[148:151], v[36:39], v[52:55], v[148:151]
    s_waitcnt lgkmcnt(7)
    v_mfma_f32_32x32x16_bf16 v[80:95], v[56:59], v[132:135], v[80:95]
    v_add_u32 v23, 0x11b00, v23
    v_add_u32 v35, 0x11b00, v35
    ds_read_b128 v[128:131], v23
    ds_read_b64_tr_b16 v[44:45], v35 offset:0
    s_add_u32 m0, s21, 28928
    s_add_u32 s17, s17, s16
    buffer_load_dwordx4 v8, s[52:55], s17 offen lds
    v_mfma_f32_32x32x16_bf16 v[96:111], v[60:63], v[132:135], v[96:111]
    ds_read_b64_tr_b16 v[46:47], v35 offset:768
    ds_read_b64_tr_b16 v[48:49], v35 offset:64
    ds_read_b64_tr_b16 v[50:51], v35 offset:832
    v_mfma_f32_32x32x16_bf16 v[112:127], v[64:67], v[132:135], v[112:127]
    ds_read_b64_tr_b16 v[52:53], v35 offset:128
    ds_read_b64_tr_b16 v[54:55], v35 offset:896
    buffer_load_dwordx4 v9, s[52:55], s17 offen offset:1024 lds
    ds_read_b128 v[156:159], v30 offset:64
    s_waitcnt lgkmcnt(8)
    v_mfma_f32_32x32x16_bf16 v[80:95], v[68:71], v[136:139], v[80:95]
    buffer_load_dwordx4 v10, s[52:55], s17 offen offset:2048 lds
    v_mfma_f32_32x32x16_bf16 v[96:111], v[72:75], v[136:139], v[96:111]
    s_waitcnt lgkmcnt(0)
    v_min3_u32 v156, v156, v157, v158
    v_min_u32 v156, v156, v159
    s_nop 0
    v_readfirstlane_b32 s10, v156
    s_nop 0
    s_cmp_lg_u32 s10, 0
    s_cbranch_scc0 LC_11
LC_12:
    s_mov_b32 s34, m0
    s_add_u32 m0, s36, 80
    s_mov_b64 exec, 1
    global_load_lds_dword v27, s[100:101]
    s_mov_b64 exec, -1
    s_mov_b32 m0, s34
    v_add_u32 v20, 0xfffe0300, v20
    v_add_u32 v32, 0xfffe0300, v32
    ds_read_b128 v[132:135], v20
    ds_read_b64_tr_b16 v[56:57], v32 offset:0
    v_mfma_f32_32x32x16_bf16 v[112:127], v[76:79], v[136:139], v[112:127]
    ds_read_b64_tr_b16 v[58:59], v32 offset:768
    ds_read_b64_tr_b16 v[60:61], v32 offset:64
    ds_read_b64_tr_b16 v[62:63], v32 offset:832
    ds_read_b64_tr_b16 v[64:65], v32 offset:128
    ds_read_b64_tr_b16 v[66:67], v32 offset:896
    s_waitcnt lgkmcnt(7)
    v_mfma_f32_32x32x16_bf16 v[80:95], v[44:47], v[128:131], v[80:95]
    v_add_u32 v21, 0xfffe0300, v21
    v_add_u32 v33, 0xfffe0300, v33
    ds_read_b128 v[136:139], v21
    ds_read_b64_tr_b16 v[68:69], v33 offset:0
    s_add_u32 s10, s35, 6
    s_and_b32 s10, s10, 7
    s_lshl_b32 s22, s10, 7
    s_add_u32 s22, s22, s19
    s_add_u32 m0, s20, 57856
    s_mul_i32 s17, s10, 176128
    buffer_load_dwordx4 v16, s[48:51], s22 offen lds
    v_mfma_f32_32x32x16_bf16 v[96:111], v[48:51], v[128:131], v[96:111]
    ds_read_b64_tr_b16 v[70:71], v33 offset:768
    ds_read_b64_tr_b16 v[72:73], v33 offset:64
    ds_read_b64_tr_b16 v[74:75], v33 offset:832
    v_mfma_f32_32x32x16_bf16 v[112:127], v[52:55], v[128:131], v[112:127]
    ds_read_b64_tr_b16 v[76:77], v33 offset:128
    ds_read_b64_tr_b16 v[78:79], v33 offset:896
    buffer_load_dwordx4 v17, s[48:51], s22 offen offset:1040 lds
    s_waitcnt lgkmcnt(7)
    v_mfma_f32_32x32x16_bf16 v[80:95], v[56:59], v[132:135], v[80:95]
    v_add_u32 v22, 0xfffe0300, v22
    v_add_u32 v34, 0xfffe0300, v34
    ds_read_b128 v[128:131], v22
    ds_read_b64_tr_b16 v[44:45], v34 offset:0
    v_mfma_f32_32x32x16_bf16 v[96:111], v[60:63], v[132:135], v[96:111]
    ds_read_b64_tr_b16 v[46:47], v34 offset:768
    ds_read_b64_tr_b16 v[48:49], v34 offset:64
    ds_read_b64_tr_b16 v[50:51], v34 offset:832
    buffer_load_dwordx4 v18, s[48:51], s22 offen offset:2080 lds
    v_mfma_f32_32x32x16_bf16 v[112:127], v[64:67], v[132:135], v[112:127]
    ds_read_b64_tr_b16 v[52:53], v34 offset:128
    ds_read_b64_tr_b16 v[54:55], v34 offset:896
    v_mfma_f32_16x16x32_bf16 v[140:143], v[36:39], v[56:59], v[140:143]
    buffer_load_dwordx4 v19, s[48:51], s22 offen offset:3120 lds
    v_mfma_f32_16x16x32_bf16 v[144:147], v[36:39], v[60:63], v[144:147]
    v_mfma_f32_16x16x32_bf16 v[148:151], v[36:39], v[64:67], v[148:151]
    s_waitcnt lgkmcnt(7)
    v_mfma_f32_32x32x16_bf16 v[80:95], v[68:71], v[136:139], v[80:95]
    v_add_u32 v23, 0xfffe0300, v23
    v_add_u32 v35, 0xfffe0300, v35
    ds_read_b128 v[132:135], v23
    ds_read_b64_tr_b16 v[56:57], v35 offset:0
    s_add_u32 m0, s21, 57856
    s_add_u32 s17, s17, s16
    buffer_load_dwordx4 v8, s[52:55], s17 offen lds
    v_mfma_f32_32x32x16_bf16 v[96:111], v[72:75], v[136:139], v[96:111]
    ds_read_b64_tr_b16 v[58:59], v35 offset:768
    ds_read_b64_tr_b16 v[60:61], v35 offset:64
    ds_read_b64_tr_b16 v[62:63], v35 offset:832
    v_mfma_f32_32x32x16_bf16 v[112:127], v[76:79], v[136:139], v[112:127]
    ds_read_b64_tr_b16 v[64:65], v35 offset:128
    ds_read_b64_tr_b16 v[66:67], v35 offset:896
    buffer_load_dwordx4 v9, s[52:55], s17 offen offset:1024 lds
    ds_read_b128 v[156:159], v30 offset:80
    s_waitcnt lgkmcnt(8)
    v_mfma_f32_32x32x16_bf16 v[80:95], v[44:47], v[128:131], v[80:95]
    buffer_load_dwordx4 v10, s[52:55], s17 offen offset:2048 lds
    v_mfma_f32_32x32x16_bf16 v[96:111], v[48:51], v[128:131], v[96:111]
    s_waitcnt lgkmcnt(0)
    v_min3_u32 v156, v156, v157, v158
    v_min_u32 v156, v156, v159
    s_nop 0
    v_readfirstlane_b32 s10, v156
    s_nop 0
    s_cmp_lg_u32 s10, 0
    s_cbranch_scc0 LC_13
LC_14:
    s_mov_b32 s34, m0
    s_add_u32 m0, s36, 96
    s_mov_b64 exec, 1
    global_load_lds_dword v27, s[100:101]
    s_mov_b64 exec, -1
    s_mov_b32 m0, s34
    v_add_u32 v20, 0x7100, v20
    v_add_u32 v32, 0x7100, v32
    ds_read_b128 v[136:139], v20
    ds_read_b64_tr_b16 v[68:69], v32 offset:0
    v_mfma_f32_32x32x16_bf16 v[112:127], v[52:55], v[128:131], v[112:127]
    ds_read_b64_tr_b16 v[70:71], v32 offset:768
    ds_read_b64_tr_b16 v[72:73], v32 offset:64
    ds_read_b64_tr_b16 v[74:75], v32 offset:832
    ds_read_b64_tr_b16 v[76:77], v32 offset:128
    ds_read_b64_tr_b16 v[78:79], v32 offset:896
    s_waitcnt lgkmcnt(7)
    v_mfma_f32_32x32x16_bf16 v[80:95], v[56:59], v[132:135], v[80:95]
    v_add_u32 v21, 0x7100, v21
    v_add_u32 v33, 0x7100, v33
    ds_read_b128 v[128:131], v21
    ds_read_b64_tr_b16 v[44:45], v33 offset:0
    s_add_u32 s10, s35, 7
    s_and_b32 s10, s10, 7
    s_lshl_b32 s22, s10, 7
    s_add_u32 s22, s22, s19
    s_add_u32 m0, s20, 130304
    s_mul_i32 s17, s10, 176128
    buffer_load_dwordx4 v16, s[48:51], s22 offen lds
    v_mfma_f32_32x32x16_bf16 v[96:111], v[60:63], v[132:135], v[96:111]
    ds_read_b64_tr_b16 v[46:47], v33 offset:768
    ds_read_b64_tr_b16 v[48:49], v33 offset:64
    ds_read_b64_tr_b16 v[50:51], v33 offset:832
    v_mfma_f32_32x32x16_bf16 v[112:127], v[64:67], v[132:135], v[112:127]
    ds_read_b64_tr_b16 v[52:53], v33 offset:128
    ds_read_b64_tr_b16 v[54:55], v33 offset:896
    buffer_load_dwordx4 v17, s[48:51], s22 offen offset:1040 lds
    s_waitcnt lgkmcnt(7)
    v_mfma_f32_32x32x16_bf16 v[80:95], v[68:71], v[136:139], v[80:95]
    v_add_u32 v22, 0x7100, v22
    v_add_u32 v34, 0x7100, v34
    ds_read_b128 v[132:135], v22
    ds_read_b64_tr_b16 v[56:57], v34 offset:0
    v_mfma_f32_32x32x16_bf16 v[96:111], v[72:75], v[136:139], v[96:111]
    ds_read_b64_tr_b16 v[58:59], v34 offset:768
    ds_read_b64_tr_b16 v[60:61], v34 offset:64
    ds_read_b64_tr_b16 v[62:63], v34 offset:832
    buffer_load_dwordx4 v18, s[48:51], s22 offen offset:2080 lds
    v_mfma_f32_32x32x16_bf16 v[112:127], v[76:79], v[136:139], v[112:127]
    ds_read_b64_tr_b16 v[64:65], v34 offset:128
    ds_read_b64_tr_b16 v[66:67], v34 offset:896
    v_mfma_f32_16x16x32_bf16 v[140:143], v[36:39], v[68:71], v[140:143]
    buffer_load_dwordx4 v19, s[48:51], s22 offen offset:3120 lds
    v_mfma_f32_16x16x32_bf16 v[144:147], v[36:39], v[72:75], v[144:147]
    v_mfma_f32_16x16x32_bf16 v[148:151], v[36:39], v[76:79], v[148:151]
    s_waitcnt lgkmcnt(7)
    v_mfma_f32_32x32x16_bf16 v[80:95], v[44:47], v[128:131], v[80:95]
    v_add_u32 v23, 0x7100, v23
    v_add_u32 v35, 0x7100, v35
    ds_read_b128 v[136:139], v23
    ds_read_b64_tr_b16 v[68:69], v35 offset:0
    s_add_u32 m0, s21, 130304
    s_add_u32 s17, s17, s16
    buffer_load_dwordx4 v8, s[52:55], s17 offen lds
    v_mfma_f32_32x32x16_bf16 v[96:111], v[48:51], v[128:131], v[96:111]
    ds_read_b64_tr_b16 v[70:71], v35 offset:768
    ds_read_b64_tr_b16 v[72:73], v35 offset:64
    ds_read_b64_tr_b16 v[74:75], v35 offset:832
    v_mfma_f32_32x32x16_bf16 v[112:127], v[52:55], v[128:131], v[112:127]
    ds_read_b64_tr_b16 v[76:77], v35 offset:128
    ds_read_b64_tr_b16 v[78:79], v35 offset:896
    buffer_load_dwordx4 v9, s[52:55], s17 offen offset:1024 lds
    ds_read_b128 v[156:159], v30 offset:96
    s_waitcnt lgkmcnt(8)
    v_mfma_f32_32x32x16_bf16 v[80:95], v[56:59], v[132:135], v[80:95]
    buffer_load_dwordx4 v10, s[52:55], s17 offen offset:2048 lds
    v_mfma_f32_32x32x16_bf16 v[96:111], v[60:63], v[132:135], v[96:111]
    s_waitcnt lgkmcnt(0)
    v_min3_u32 v156, v156, v157, v158
    v_min_u32 v156, v156, v159
    s_nop 0
    v_readfirstlane_b32 s10, v156
    s_nop 0
    s_cmp_lg_u32 s10, 0
    s_cbranch_scc0 LC_15
LC_16:
    s_mov_b32 s34, m0
    s_add_u32 m0, s36, 112
    s_mov_b64 exec, 1
    global_load_lds_dword v27, s[100:101]
    s_mov_b64 exec, -1
    s_mov_b32 m0, s34
    v_add_u32 v20, 0x7100, v20
    v_add_u32 v32, 0x7100, v32
    ds_read_b128 v[128:131], v20
    ds_read_b64_tr_b16 v[44:45], v32 offset:0
    v_mfma_f32_32x32x16_bf16 v[112:127], v[64:67], v[132:135], v[112:127]
    ds_read_b64_tr_b16 v[46:47], v32 offset:768
    ds_read_b64_tr_b16 v[48:49], v32 offset:64
    ds_read_b64_tr_b16 v[50:51], v32 offset:832
    ds_read_b64_tr_b16 v[52:53], v32 offset:128
    ds_read_b64_tr_b16 v[54:55], v32 offset:896
    buffer_load_dwordx2 v[152:153], v40, s[44:47], s27 offen sc1
    s_waitcnt lgkmcnt(7)
    v_mfma_f32_32x32x16_bf16 v[80:95], v[68:71], v[136:139], v[80:95]
    v_add_u32 v21, 0x7100, v21
    v_add_u32 v33, 0x7100, v33
    ds_read_b128 v[132:135], v21
    ds_read_b64_tr_b16 v[56:57], v33 offset:0
    s_add_u32 s40, s40, 16384
    buffer_load_dwordx4 v[184:187], v16, s[56:59], s40 offen
    v_mfma_f32_32x32x16_bf16 v[96:111], v[72:75], v[136:139], v[96:111]
    ds_read_b64_tr_b16 v[58:59], v33 offset:768
    ds_read_b64_tr_b16 v[60:61], v33 offset:64
    ds_read_b64_tr_b16 v[62:63], v33 offset:832
    v_mfma_f32_32x32x16_bf16 v[112:127], v[76:79], v[136:139], v[112:127]
    ds_read_b64_tr_b16 v[64:65], v33 offset:128
    ds_read_b64_tr_b16 v[66:67], v33 offset:896
    buffer_load_dwordx4 v[188:191], v25, s[56:59], s40 offen offset:1024
    s_waitcnt lgkmcnt(7)
    v_mfma_f32_32x32x16_bf16 v[80:95], v[44:47], v[128:131], v[80:95]
    v_add_u32 v22, 0x7100, v22
    v_add_u32 v34, 0x7100, v34
    ds_read_b128 v[136:139], v22
    ds_read_b64_tr_b16 v[68:69], v34 offset:0
    v_mfma_f32_32x32x16_bf16 v[96:111], v[48:51], v[128:131], v[96:111]
    ds_read_b64_tr_b16 v[70:71], v34 offset:768
    ds_read_b64_tr_b16 v[72:73], v34 offset:64
    ds_read_b64_tr_b16 v[74:75], v34 offset:832
    s_add_u32 s40, s40, 16384
    buffer_load_dwordx4 v[192:195], v16, s[56:59], s40 offen
    v_mfma_f32_32x32x16_bf16 v[112:127], v[52:55], v[128:131], v[112:127]
    ds_read_b64_tr_b16 v[76:77], v34 offset:128
    ds_read_b64_tr_b16 v[78:79], v34 offset:896
    v_mfma_f32_16x16x32_bf16 v[140:143], v[36:39], v[44:47], v[140:143]
    buffer_load_dwordx4 v[196:199], v25, s[56:59], s40 offen offset:1024
    v_mfma_f32_16x16x32_bf16 v[144:147], v[36:39], v[48:51], v[144:147]
    v_mfma_f32_16x16x32_bf16 v[148:151], v[36:39], v[52:55], v[148:151]
    s_waitcnt lgkmcnt(7)
    v_mfma_f32_32x32x16_bf16 v[80:95], v[56:59], v[132:135], v[80:95]
    v_add_u32 v23, 0x7100, v23
    v_add_u32 v35, 0x7100, v35
    ds_read_b128 v[128:131], v23
    ds_read_b64_tr_b16 v[44:45], v35 offset:0
    s_add_u32 s40, s40, 16384
    buffer_load_dwordx4 v[200:203], v16, s[56:59], s40 offen
    v_mfma_f32_32x32x16_bf16 v[96:111], v[60:63], v[132:135], v[96:111]
    ds_read_b64_tr_b16 v[46:47], v35 offset:768
    ds_read_b64_tr_b16 v[48:49], v35 offset:64
    ds_read_b64_tr_b16 v[50:51], v35 offset:832
    v_mfma_f32_32x32x16_bf16 v[112:127], v[64:67], v[132:135], v[112:127]
    ds_read_b64_tr_b16 v[52:53], v35 offset:128
    ds_read_b64_tr_b16 v[54:55], v35 offset:896
    buffer_load_dwordx4 v[204:207], v25, s[56:59], s40 offen offset:1024
    ds_read_b128 v[156:159], v30 offset:112
    s_waitcnt lgkmcnt(8)
    v_mfma_f32_32x32x16_bf16 v[80:95], v[68:71], v[136:139], v[80:95]
    s_add_u32 s40, s40, 16384
    buffer_load_dwordx4 v[208:211], v16, s[56:59], s40 offen
    v_mfma_f32_32x32x16_bf16 v[96:111], v[72:75], v[136:139], v[96:111]
    s_waitcnt lgkmcnt(0)
    v_min3_u32 v156, v156, v157, v158
    v_min_u32 v156, v156, v159
    s_nop 0
    v_readfirstlane_b32 s10, v156
    s_nop 0
    s_cmp_lg_u32 s10, 0
    s_cbranch_scc0 LC_17
LC_18:
    v_add_u32 v20, 0x11b00, v20
    v_add_u32 v32, 0x11b00, v32
    ds_read_b128 v[132:135], v20
    ds_read_b64_tr_b16 v[56:57], v32 offset:0
    v_mfma_f32_32x32x16_bf16 v[112:127], v[76:79], v[136:139], v[112:127]
    ds_read_b64_tr_b16 v[58:59], v32 offset:768
    ds_read_b64_tr_b16 v[60:61], v32 offset:64
    ds_read_b64_tr_b16 v[62:63], v32 offset:832
    ds_read_b64_tr_b16 v[64:65], v32 offset:128
    ds_read_b64_tr_b16 v[66:67], v32 offset:896
    buffer_load_dwordx4 v[212:215], v25, s[56:59], s40 offen offset:1024
    s_waitcnt lgkmcnt(7)
    v_mfma_f32_32x32x16_bf16 v[80:95], v[44:47], v[128:131], v[80:95]
    v_add_u32 v21, 0x11b00, v21
    v_add_u32 v33, 0x11b00, v33
    ds_read_b128 v[136:139], v21
    ds_read_b64_tr_b16 v[68:69], v33 offset:0
    s_add_u32 s40, s40, 16384
    buffer_load_dwordx4 v[216:219], v16, s[56:59], s40 offen
    v_mfma_f32_32x32x16_bf16 v[96:111], v[48:51], v[128:131], v[96:111]
    ds_read_b64_tr_b16 v[70:71], v33 offset:768
    ds_read_b64_tr_b16 v[72:73], v33 offset:64
    ds_read_b64_tr_b16 v[74:75], v33 offset:832
    v_mfma_f32_32x32x16_bf16 v[112:127], v[52:55], v[128:131], v[112:127]
    ds_read_b64_tr_b16 v[76:77], v33 offset:128
    ds_read_b64_tr_b16 v[78:79], v33 offset:896
    buffer_load_dwordx4 v[220:223], v25, s[56:59], s40 offen offset:1024
    s_waitcnt lgkmcnt(7)
    v_mfma_f32_16x16x32_bf16 v[140:143], v[36:39], v[56:59], v[140:143]
    v_mfma_f32_16x16x32_bf16 v[144:147], v[36:39], v[60:63], v[144:147]
    v_mfma_f32_16x16x32_bf16 v[148:151], v[36:39], v[64:67], v[148:151]
    v_mfma_f32_32x32x16_bf16 v[80:95], v[56:59], v[132:135], v[80:95]
    v_add_u32 v22, 0x11b00, v22
    v_add_u32 v34, 0x11b00, v34
    ds_read_b128 v[128:131], v22
    ds_read_b64_tr_b16 v[44:45], v34 offset:0
    ds_read_b64_tr_b16 v[46:47], v34 offset:768
    ds_read_b64_tr_b16 v[48:49], v34 offset:64
    v_mfma_f32_32x32x16_bf16 v[96:111], v[60:63], v[132:135], v[96:111]
    ds_read_b64_tr_b16 v[50:51], v34 offset:832
    ds_read_b64_tr_b16 v[52:53], v34 offset:128
    ds_read_b64_tr_b16 v[54:55], v34 offset:896
    s_add_u32 s40, s40, 16384
    buffer_load_dwordx4 v[224:227], v16, s[56:59], s40 offen
    v_mfma_f32_32x32x16_bf16 v[112:127], v[64:67], v[132:135], v[112:127]
    v_cvt_pk_bf16_f32 v154, v140, v140
    v_and_b32 v155, s13, v154
    v_sub_f32 v155, v140, v155
    v_cvt_pk_bf16_f32 v154, v140, v155
    ds_write_b32 v41, v154 offset:0
    s_waitcnt lgkmcnt(8)
    v_mfma_f32_32x32x16_bf16 v[80:95], v[68:71], v[136:139], v[80:95]
    v_cvt_pk_bf16_f32 v154, v144, v144
    v_and_b32 v155, s13, v154
    v_sub_f32 v155, v144, v155
    v_cvt_pk_bf16_f32 v154, v144, v155
    ds_write_b32 v41, v154 offset:512
    buffer_load_dwordx4 v[228:231], v25, s[56:59], s40 offen offset:1024
    v_mfma_f32_32x32x16_bf16 v[96:111], v[72:75], v[136:139], v[96:111]
    v_cvt_pk_bf16_f32 v154, v148, v148
    v_and_b32 v155, s13, v154
    v_sub_f32 v155, v148, v155
    v_cvt_pk_bf16_f32 v154, v148, v155
    ds_write_b32 v41, v154 offset:7168
    v_mfma_f32_32x32x16_bf16 v[112:127], v[76:79], v[136:139], v[112:127]
    v_add_u32 v23, 0x11b00, v23
    v_add_u32 v35, 0x11b00, v35
    ds_read_b128 v[132:135], v23
    ds_read_b64_tr_b16 v[56:57], v35 offset:0
    ds_read_b64_tr_b16 v[58:59], v35 offset:768
    ds_read_b64_tr_b16 v[60:61], v35 offset:64
    ds_read_b64_tr_b16 v[62:63], v35 offset:832
    ds_read_b64_tr_b16 v[64:65], v35 offset:128
    ds_read_b64_tr_b16 v[66:67], v35 offset:896
    s_mov_b64 exec, 1
    ds_add_u32 v43, v31 offset:0
    s_mov_b64 exec, -1
    s_waitcnt lgkmcnt(11)
    v_mfma_f32_32x32x16_bf16 v[80:95], v[44:47], v[128:131], v[80:95]
    s_add_u32 s40, s40, 16384
    buffer_load_dwordx4 v[232:235], v16, s[56:59], s40 offen
    s_waitcnt vmcnt(13)
    v_cmp_ne_u32 vcc, s9, v153
    s_nop 0
    s_cbranch_vccnz LS_19
LS_21:
    v_mfma_f32_32x32x16_bf16 v[96:111], v[48:51], v[128:131], v[96:111]
    v_and_b32 v160, 0xffff, v152
    v_cmp_eq_u32 vcc, 0, v3
    v_lshl_or_b32 v160, v160, 16, v160
    v_xor_b32 v160, 0x80008000, v160
    v_and_b32 v37, s13, v152
    v_cndmask_b32 v160, 0, v160, vcc
    v_mfma_f32_32x32x16_bf16 v[112:127], v[52:55], v[128:131], v[112:127]
    buffer_load_dwordx4 v[236:239], v25, s[56:59], s40 offen offset:1024
    v_rcp_f32 v37, v37
    v_mov_b32 v161, v160
    v_mov_b32 v162, v160
    v_mov_b32 v163, v160
    v_mul_f32 v36, 0xbfb8aa3b, v37
    s_waitcnt lgkmcnt(1)
    v_mfma_f32_32x32x16_bf16 v[80:95], v[56:59], v[132:135], v[80:95]
    ds_read_b32 v11, v43 offset:0
    s_waitcnt lgkmcnt(0)
    v_readfirstlane_b32 s10, v11
    s_nop 0
    s_cmp_ge_u32 s10, 4
    s_cbranch_scc0 LW_22
LW_23:
    ds_read_b128 v[168:171], v42 offset:0
    ds_read_b128 v[172:175], v42 offset:512
    ds_read_b128 v[176:179], v42 offset:7168
    v_mfma_f32_32x32x16_bf16 v[96:111], v[60:63], v[132:135], v[96:111]
    s_add_u32 s40, s40, 16384
    buffer_load_dwordx4 v[240:243], v16, s[56:59], s40 offen
    v_mfma_f32_32x32x16_bf16 v[112:127], v[64:67], v[132:135], v[112:127]
    buffer_load_dwordx4 v[244:247], v25, s[56:59], s40 offen offset:1024
    s_waitcnt lgkmcnt(2)
    v_mfma_f32_32x32x16_bf16 v[80:95], v[168:171], v[160:163], v[80:95]
    s_waitcnt lgkmcnt(1)
    v_mfma_f32_32x32x16_bf16 v[96:111], v[172:175], v[160:163], v[96:111]
    s_waitcnt lgkmcnt(0)
    v_mfma_f32_32x32x16_bf16 v[112:127], v[176:179], v[160:163], v[112:127]
    s_lshl_b32 s10, s3, 2
    s_add_u32 s10, s10, 130064
    v_mov_b32 v29, s10
    v_mov_b32 v44, s9
    v_mov_b32 v45, s9
    v_mov_b32 v46, s9
    v_mov_b32 v47, s9
    s_nop 0
    v_pk_mul_f32 v[128:129], v[80:81], v[36:37] op_sel_hi:[1,0]
    v_pk_mul_f32 v[130:131], v[82:83], v[36:37] op_sel_hi:[1,0]
    v_pk_mul_f32 v[132:133], v[84:85], v[36:37] op_sel_hi:[1,0]
    v_pk_mul_f32 v[134:135], v[86:87], v[36:37] op_sel_hi:[1,0]
    v_exp_f32 v128, v128
    v_exp_f32 v129, v129
    v_exp_f32 v130, v130
    v_exp_f32 v131, v131
    v_exp_f32 v132, v132
    v_exp_f32 v133, v133
    v_exp_f32 v134, v134
    v_exp_f32 v135, v135
    v_pk_add_f32 v[128:129], v[128:129], 1.0 op_sel_hi:[1,0]
    v_pk_add_f32 v[130:131], v[130:131], 1.0 op_sel_hi:[1,0]
    v_pk_add_f32 v[132:133], v[132:133], 1.0 op_sel_hi:[1,0]
    v_pk_add_f32 v[134:135], v[134:135], 1.0 op_sel_hi:[1,0]
    v_rcp_f32 v128, v128
    v_rcp_f32 v129, v129
    v_rcp_f32 v130, v130
    v_rcp_f32 v131, v131
    v_rcp_f32 v132, v132
    v_rcp_f32 v133, v133
    v_rcp_f32 v134, v134
    v_rcp_f32 v135, v135
    v_pk_mul_f32 v[80:81], v[80:81], v[36:37] op_sel:[0,1] op_sel_hi:[1,1]
    v_pk_mul_f32 v[82:83], v[82:83], v[36:37] op_sel:[0,1] op_sel_hi:[1,1]
    v_pk_mul_f32 v[84:85], v[84:85], v[36:37] op_sel:[0,1] op_sel_hi:[1,1]
    v_pk_mul_f32 v[86:87], v[86:87], v[36:37] op_sel:[0,1] op_sel_hi:[1,1]
    v_pk_mul_f32 v[128:129], v[128:129], v[80:81]
    v_pk_mul_f32 v[130:131], v[130:131], v[82:83]
    v_pk_mul_f32 v[132:133], v[132:133], v[84:85]
    v_pk_mul_f32 v[134:135], v[134:135], v[86:87]
    v_cvt_pk_bf16_f32 v144, v128, v129
    v_cvt_pk_bf16_f32 v145, v130, v131
    v_cvt_pk_bf16_f32 v146, v132, v133
    v_cvt_pk_bf16_f32 v147, v134, v135
    buffer_store_dwordx4 v[144:147], v26, s[44:47], s26 offen offset:0 sc1
    v_add3_u32 v44, v144, v145, v44
    v_add3_u32 v44, v146, v147, v44
    v_pk_mul_f32 v[136:137], v[88:89], v[36:37] op_sel_hi:[1,0]
    v_pk_mul_f32 v[138:139], v[90:91], v[36:37] op_sel_hi:[1,0]
    v_pk_mul_f32 v[140:141], v[92:93], v[36:37] op_sel_hi:[1,0]
    v_pk_mul_f32 v[142:143], v[94:95], v[36:37] op_sel_hi:[1,0]
    v_exp_f32 v136, v136
    v_exp_f32 v137, v137
    v_exp_f32 v138, v138
    v_exp_f32 v139, v139
    v_exp_f32 v140, v140
    v_exp_f32 v141, v141
    v_exp_f32 v142, v142
    v_exp_f32 v143, v143
    v_pk_add_f32 v[136:137], v[136:137], 1.0 op_sel_hi:[1,0]
    v_pk_add_f32 v[138:139], v[138:139], 1.0 op_sel_hi:[1,0]
    v_pk_add_f32 v[140:141], v[140:141], 1.0 op_sel_hi:[1,0]
    v_pk_add_f32 v[142:143], v[142:143], 1.0 op_sel_hi:[1,0]
    v_rcp_f32 v136, v136
    v_rcp_f32 v137, v137
    v_rcp_f32 v138, v138
    v_rcp_f32 v139, v139
    v_rcp_f32 v140, v140
    v_rcp_f32 v141, v141
    v_rcp_f32 v142, v142
    v_rcp_f32 v143, v143
    v_pk_mul_f32 v[88:89], v[88:89], v[36:37] op_sel:[0,1] op_sel_hi:[1,1]
    v_pk_mul_f32 v[90:91], v[90:91], v[36:37] op_sel:[0,1] op_sel_hi:[1,1]
    v_pk_mul_f32 v[92:93], v[92:93], v[36:37] op_sel:[0,1] op_sel_hi:[1,1]
    v_pk_mul_f32 v[94:95], v[94:95], v[36:37] op_sel:[0,1] op_sel_hi:[1,1]
    v_pk_mul_f32 v[136:137], v[136:137], v[88:89]
    v_pk_mul_f32 v[138:139], v[138:139], v[90:91]
    v_pk_mul_f32 v[140:141], v[140:141], v[92:93]
    v_pk_mul_f32 v[142:143], v[142:143], v[94:95]
    v_cvt_pk_bf16_f32 v148, v136, v137
    v_cvt_pk_bf16_f32 v149, v138, v139
    v_cvt_pk_bf16_f32 v150, v140, v141
    v_cvt_pk_bf16_f32 v151, v142, v143
    buffer_store_dwordx4 v[148:151], v26, s[44:47], s26 offen offset:1024 sc1
    v_add3_u32 v44, v148, v149, v44
    v_add3_u32 v44, v150, v151, v44
    s_add_u32 s26, s26, 163840
    s_cmp_lt_u32 s5, 8
    s_cbranch_scc1 L_mir1
    v_pk_mul_f32 v[128:129], v[96:97], v[36:37] op_sel_hi:[1,0]
    v_pk_mul_f32 v[130:131], v[98:99], v[36:37] op_sel_hi:[1,0]
    v_pk_mul_f32 v[132:133], v[100:101], v[36:37] op_sel_hi:[1,0]
    v_pk_mul_f32 v[134:135], v[102:103], v[36:37] op_sel_hi:[1,0]
    v_exp_f32 v128, v128
    v_exp_f32 v129, v129
    v_exp_f32 v130, v130
    v_exp_f32 v131, v131
    v_exp_f32 v132, v132
    v_exp_f32 v133, v133
    v_exp_f32 v134, v134
    v_exp_f32 v135, v135
    v_pk_add_f32 v[128:129], v[128:129], 1.0 op_sel_hi:[1,0]
    v_pk_add_f32 v[130:131], v[130:131], 1.0 op_sel_hi:[1,0]
    v_pk_add_f32 v[132:133], v[132:133], 1.0 op_sel_hi:[1,0]
    v_pk_add_f32 v[134:135], v[134:135], 1.0 op_sel_hi:[1,0]
    v_rcp_f32 v128, v128
    v_rcp_f32 v129, v129
    v_rcp_f32 v130, v130
    v_rcp_f32 v131, v131
    v_rcp_f32 v132, v132
    v_rcp_f32 v133, v133
    v_rcp_f32 v134, v134
    v_rcp_f32 v135, v135
    v_pk_mul_f32 v[96:97], v[96:97], v[36:37] op_sel:[0,1] op_sel_hi:[1,1]
    v_pk_mul_f32 v[98:99], v[98:99], v[36:37] op_sel:[0,1] op_sel_hi:[1,1]
    v_pk_mul_f32 v[100:101], v[100:101], v[36:37] op_sel:[0,1] op_sel_hi:[1,1]
    v_pk_mul_f32 v[102:103], v[102:103], v[36:37] op_sel:[0,1] op_sel_hi:[1,1]
    v_pk_mul_f32 v[128:129], v[128:129], v[96:97]
    v_pk_mul_f32 v[130:131], v[130:131], v[98:99]
    v_pk_mul_f32 v[132:133], v[132:133], v[100:101]
    v_pk_mul_f32 v[134:135], v[134:135], v[102:103]
    v_cvt_pk_bf16_f32 v152, v128, v129
    v_cvt_pk_bf16_f32 v153, v130, v131
    v_cvt_pk_bf16_f32 v154, v132, v133
    v_cvt_pk_bf16_f32 v155, v134, v135
    buffer_store_dwordx4 v[152:155], v26, s[44:47], s26 offen offset:0 sc1
    v_add3_u32 v45, v152, v153, v45
    v_add3_u32 v45, v154, v155, v45
    v_pk_mul_f32 v[136:137], v[104:105], v[36:37] op_sel_hi:[1,0]
    v_pk_mul_f32 v[138:139], v[106:107], v[36:37] op_sel_hi:[1,0]
    v_pk_mul_f32 v[140:141], v[108:109], v[36:37] op_sel_hi:[1,0]
    v_pk_mul_f32 v[142:143], v[110:111], v[36:37] op_sel_hi:[1,0]
    v_exp_f32 v136, v136
    v_exp_f32 v137, v137
    v_exp_f32 v138, v138
    v_exp_f32 v139, v139
    v_exp_f32 v140, v140
    v_exp_f32 v141, v141
    v_exp_f32 v142, v142
    v_exp_f32 v143, v143
    v_pk_add_f32 v[136:137], v[136:137], 1.0 op_sel_hi:[1,0]
    v_pk_add_f32 v[138:139], v[138:139], 1.0 op_sel_hi:[1,0]
    v_pk_add_f32 v[140:141], v[140:141], 1.0 op_sel_hi:[1,0]
    v_pk_add_f32 v[142:143], v[142:143], 1.0 op_sel_hi:[1,0]
    v_rcp_f32 v136, v136
    v_rcp_f32 v137, v137
    v_rcp_f32 v138, v138
    v_rcp_f32 v139, v139
    v_rcp_f32 v140, v140
    v_rcp_f32 v141, v141
    v_rcp_f32 v142, v142
    v_rcp_f32 v143, v143
    v_pk_mul_f32 v[104:105], v[104:105], v[36:37] op_sel:[0,1] op_sel_hi:[1,1]
    v_pk_mul_f32 v[106:107], v[106:107], v[36:37] op_sel:[0,1] op_sel_hi:[1,1]
    v_pk_mul_f32 v[108:109], v[108:109], v[36:37] op_sel:[0,1] op_sel_hi:[1,1]
    v_pk_mul_f32 v[110:111], v[110:111], v[36:37] op_sel:[0,1] op_sel_hi:[1,1]
    v_pk_mul_f32 v[136:137], v[136:137], v[104:105]
    v_pk_mul_f32 v[138:139], v[138:139], v[106:107]
    v_pk_mul_f32 v[140:141], v[140:141], v[108:109]
    v_pk_mul_f32 v[142:143], v[142:143], v[110:111]
    v_cvt_pk_bf16_f32 v156, v136, v137
    v_cvt_pk_bf16_f32 v157, v138, v139
    v_cvt_pk_bf16_f32 v158, v140, v141
    v_cvt_pk_bf16_f32 v159, v142, v143
    buffer_store_dwordx4 v[156:159], v26, s[44:47], s26 offen offset:1024 sc1
    v_add3_u32 v45, v156, v157, v45
    v_add3_u32 v45, v158, v159, v45
    s_add_u32 s26, s26, 163840
    s_cmp_lt_u32 s5, 12
    s_cbranch_scc1 L_mir2
    v_pk_mul_f32 v[128:129], v[112:113], v[36:37] op_sel_hi:[1,0]
    v_pk_mul_f32 v[130:131], v[114:115], v[36:37] op_sel_hi:[1,0]
    v_pk_mul_f32 v[132:133], v[116:117], v[36:37] op_sel_hi:[1,0]
    v_pk_mul_f32 v[134:135], v[118:119], v[36:37] op_sel_hi:[1,0]
    v_exp_f32 v128, v128
    v_exp_f32 v129, v129
    v_exp_f32 v130, v130
    v_exp_f32 v131, v131
    v_exp_f32 v132, v132
    v_exp_f32 v133, v133
    v_exp_f32 v134, v134
    v_exp_f32 v135, v135
    v_pk_add_f32 v[128:129], v[128:129], 1.0 op_sel_hi:[1,0]
    v_pk_add_f32 v[130:131], v[130:131], 1.0 op_sel_hi:[1,0]
    v_pk_add_f32 v[132:133], v[132:133], 1.0 op_sel_hi:[1,0]
    v_pk_add_f32 v[134:135], v[134:135], 1.0 op_sel_hi:[1,0]
    v_rcp_f32 v128, v128
    v_rcp_f32 v129, v129
    v_rcp_f32 v130, v130
    v_rcp_f32 v131, v131
    v_rcp_f32 v132, v132
    v_rcp_f32 v133, v133
    v_rcp_f32 v134, v134
    v_rcp_f32 v135, v135
    v_pk_mul_f32 v[112:113], v[112:113], v[36:37] op_sel:[0,1] op_sel_hi:[1,1]
    v_pk_mul_f32 v[114:115], v[114:115], v[36:37] op_sel:[0,1] op_sel_hi:[1,1]
    v_pk_mul_f32 v[116:117], v[116:117], v[36:37] op_sel:[0,1] op_sel_hi:[1,1]
    v_pk_mul_f32 v[118:119], v[118:119], v[36:37] op_sel:[0,1] op_sel_hi:[1,1]
    v_pk_mul_f32 v[128:129], v[128:129], v[112:113]
    v_pk_mul_f32 v[130:131], v[130:131], v[114:115]
    v_pk_mul_f32 v[132:133], v[132:133], v[116:117]
    v_pk_mul_f32 v[134:135], v[134:135], v[118:119]
    v_cvt_pk_bf16_f32 v160, v128, v129
    v_cvt_pk_bf16_f32 v161, v130, v131
    v_cvt_pk_bf16_f32 v162, v132, v133
    v_cvt_pk_bf16_f32 v163, v134, v135
    buffer_store_dwordx4 v[160:163], v26, s[44:47], s26 offen offset:0 sc1
    v_add3_u32 v46, v160, v161, v46
    v_add3_u32 v46, v162, v163, v46
    v_pk_mul_f32 v[136:137], v[120:121], v[36:37] op_sel_hi:[1,0]
    v_pk_mul_f32 v[138:139], v[122:123], v[36:37] op_sel_hi:[1,0]
    v_pk_mul_f32 v[140:141], v[124:125], v[36:37] op_sel_hi:[1,0]
    v_pk_mul_f32 v[142:143], v[126:127], v[36:37] op_sel_hi:[1,0]
    v_exp_f32 v136, v136
    v_exp_f32 v137, v137
    v_exp_f32 v138, v138
    v_exp_f32 v139, v139
    v_exp_f32 v140, v140
    v_exp_f32 v141, v141
    v_exp_f32 v142, v142
    v_exp_f32 v143, v143
    v_pk_add_f32 v[136:137], v[136:137], 1.0 op_sel_hi:[1,0]
    v_pk_add_f32 v[138:139], v[138:139], 1.0 op_sel_hi:[1,0]
    v_pk_add_f32 v[140:141], v[140:141], 1.0 op_sel_hi:[1,0]
    v_pk_add_f32 v[142:143], v[142:143], 1.0 op_sel_hi:[1,0]
    v_rcp_f32 v136, v136
    v_rcp_f32 v137, v137
    v_rcp_f32 v138, v138
    v_rcp_f32 v139, v139
    v_rcp_f32 v140, v140
    v_rcp_f32 v141, v141
    v_rcp_f32 v142, v142
    v_rcp_f32 v143, v143
    v_pk_mul_f32 v[120:121], v[120:121], v[36:37] op_sel:[0,1] op_sel_hi:[1,1]
    v_pk_mul_f32 v[122:123], v[122:123], v[36:37] op_sel:[0,1] op_sel_hi:[1,1]
    v_pk_mul_f32 v[124:125], v[124:125], v[36:37] op_sel:[0,1] op_sel_hi:[1,1]
    v_pk_mul_f32 v[126:127], v[126:127], v[36:37] op_sel:[0,1] op_sel_hi:[1,1]
    v_pk_mul_f32 v[136:137], v[136:137], v[120:121]
    v_pk_mul_f32 v[138:139], v[138:139], v[122:123]
    v_pk_mul_f32 v[140:141], v[140:141], v[124:125]
    v_pk_mul_f32 v[142:143], v[142:143], v[126:127]
    v_cvt_pk_bf16_f32 v164, v136, v137
    v_cvt_pk_bf16_f32 v165, v138, v139
    v_cvt_pk_bf16_f32 v166, v140, v141
    v_cvt_pk_bf16_f32 v167, v142, v143
    buffer_store_dwordx4 v[164:167], v26, s[44:47], s26 offen offset:1024 sc1
    v_add3_u32 v46, v164, v165, v46
    v_add3_u32 v46, v166, v167, v46
L_skipu2:
    v_mov_b32 v48, v44
    v_mov_b32 v49, v45
    v_mov_b32 v50, v46
    v_permlane16_swap_b32 v44, v48
    v_permlane16_swap_b32 v45, v49
    v_permlane16_swap_b32 v46, v50
    v_add_u32 v44, v44, v48
    v_add_u32 v45, v45, v49
    v_add_u32 v46, v46, v50
    s_mov_b32 exec_lo, 0xffff
    s_mov_b32 exec_hi, 0xffff
    buffer_store_dwordx4 v[44:47], v26, s[44:47], s94 offen sc1
    s_mov_b64 exec, -1
    ds_write_b32 v29, v31
    v_add_u32 v30, s23, v26
    s_add_u32 s40, s40, 16384
    buffer_load_dwordx4 v[248:251], v16, s[56:59], s40 offen
    s_lshl_b32 s10, s7, 16
    s_lshl_b32 s11, s3, 14
    s_add_u32 s29, s10, s11
    buffer_load_dwordx4 v[252:255], v25, s[56:59], s40 offen offset:1024
    s_lshl_b32 s11, s8, 7
    s_add_u32 s29, s29, s11
    s_add_u32 s30, s29, 8192
    s_add_u32 m0, s23, 0
    s_add_u32 s25, s25, 16384
    buffer_load_dwordx4 v16, s[56:59], s25 offen lds
    v_mul_u32_u24 v17, 4096, v5
    v_lshl_add_u32 v17, v6, 4, v17
    s_mul_i32 s10, s8, 262144
    buffer_load_dwordx4 v25, s[56:59], s25 offen offset:1024 lds
    s_mul_i32 s11, s3, 65536
    s_add_u32 s34, s10, s11
    s_lshl_b32 s11, s7, 7
    s_add_u32 m0, s23, 2048
    s_add_u32 s25, s25, 16384
    buffer_load_dwordx4 v16, s[56:59], s25 offen lds
    s_add_u32 s34, s34, s11
    s_lshr_b32 s31, s34, 2
    s_add_u32 s31, s31, 393216
    buffer_load_dwordx4 v25, s[56:59], s25 offen offset:1024 lds
    s_add_u32 s32, s31, 8192
    s_add_u32 s34, s34, 4980736
    s_add_u32 s33, s34, 32768
    s_add_u32 m0, s23, 4096
    s_add_u32 s25, s25, 16384
    buffer_load_dwordx4 v16, s[56:59], s25 offen lds
    v_mul_u32_u24 v18, 144, v5
    v_lshl_add_u32 v18, v6, 4, v18
    s_lshl_b32 s10, s3, 4
    buffer_load_dwordx4 v25, s[56:59], s25 offen offset:1024 lds
    s_add_u32 s10, s10, s24
    v_add_u32 v18, s10, v18
    v_lshrrev_b32 v19, 1, v6
    s_add_u32 m0, s23, 28928
    s_add_u32 s25, s25, 16384
    buffer_load_dwordx4 v16, s[56:59], s25 offen lds
    v_mul_u32_u24 v19, 8336, v19
    v_and_b32 v20, 1, v6
    v_mul_u32_u24 v20, 1216, v20
    buffer_load_dwordx4 v25, s[56:59], s25 offen offset:1024 lds
    v_add_u32 v19, v19, v20
    v_lshl_add_u32 v19, v5, 1, v19
    s_lshl_b32 s10, s3, 5
    s_add_u32 m0, s23, 30976
    s_add_u32 s25, s25, 16384
    buffer_load_dwordx4 v16, s[56:59], s25 offen lds
    s_add_u32 s10, s10, 130304
    v_add_u32 v19, s10, v19
    v_and_b32 v20, 1, v5
    buffer_load_dwordx4 v25, s[56:59], s25 offen offset:1024 lds
    v_mul_u32_u24 v20, 272, v20
    v_bfe_u32 v21, v5, 1, 1
    v_mul_u32_u24 v21, 640, v21
    s_add_u32 m0, s23, 33024
    s_add_u32 s25, s25, 16384
    buffer_load_dwordx4 v16, s[56:59], s25 offen lds
    v_add_u32 v20, v20, v21
    v_lshl_add_u32 v20, v3, 7, v20
    v_lshrrev_b32 v21, 2, v6
    buffer_load_dwordx4 v25, s[56:59], s25 offen offset:1024 lds
    v_mul_u32_u24 v21, 1280, v21
    v_add_u32 v20, v20, v21
    v_lshl_add_u32 v20, v2, 5, v20
    s_add_u32 m0, s23, 57856
    s_add_u32 s25, s25, 16384
    buffer_load_dwordx4 v16, s[56:59], s25 offen lds
    s_mul_i32 s10, s3, 4896
    v_add_u32 v20, s10, v20
    v_lshrrev_b32 v21, 2, v17
    buffer_load_dwordx4 v25, s[56:59], s25 offen offset:1024 lds
    v_add_u32 v28, 4096, v26
    s_mov_b32 s35, s28
    v_mov_b32 v22, v29
    s_add_u32 m0, s23, 59904
    s_add_u32 s25, s25, 16384
    buffer_load_dwordx4 v16, s[56:59], s25 offen lds
    v_mov_b32 v29, 130060
    buffer_load_dwordx4 v25, s[56:59], s25 offen offset:1024 lds
    s_add_u32 m0, s23, 61952
    s_add_u32 s25, s25, 16384
    buffer_load_dwordx4 v16, s[56:59], s25 offen lds
    buffer_load_dwordx4 v25, s[56:59], s25 offen offset:1024 lds
    s_add_u32 m0, s24, 0
    s_add_u32 s25, s25, 16384
    buffer_load_dwordx4 v16, s[56:59], s25 offen lds
    buffer_load_dwordx4 v25, s[56:59], s25 offen offset:1024 lds
    s_add_u32 m0, s24, 2048
    s_add_u32 s25, s25, 16384
    buffer_load_dwordx4 v16, s[56:59], s25 offen lds
    buffer_load_dwordx4 v25, s[56:59], s25 offen offset:1024 lds
    s_add_u32 m0, s24, 4096
    s_add_u32 s25, s25, 16384
    buffer_load_dwordx4 v16, s[56:59], s25 offen lds
    buffer_load_dwordx4 v25, s[56:59], s25 offen offset:1024 lds
    s_add_u32 m0, s24, 6144
    s_add_u32 s25, s25, 16384
    buffer_load_dwordx4 v16, s[56:59], s25 offen lds
    buffer_load_dwordx4 v25, s[56:59], s25 offen offset:1024 lds
    s_add_u32 s28, s28, 163840
    buffer_load_dwordx4 v[48:51], v26, s[44:47], s28 offen offset:0 sc1
    buffer_load_dwordx4 v[52:55], v26, s[44:47], s28 offen offset:1024 sc1
    buffer_load_dwordx4 v[56:59], v26, s[44:47], s28 offen offset:2048 sc1
    buffer_load_dwordx4 v[60:63], v26, s[44:47], s28 offen offset:3072 sc1
    buffer_load_dwordx4 v[2:5], v28, s[44:47], s28 offen sc1
    s_add_u32 s28, s28, 163840
    buffer_load_dwordx4 v[64:67], v26, s[44:47], s28 offen offset:0 sc1
    buffer_load_dwordx4 v[68:71], v26, s[44:47], s28 offen offset:1024 sc1
    buffer_load_dwordx4 v[72:75], v26, s[44:47], s28 offen offset:2048 sc1
    buffer_load_dwordx4 v[76:79], v26, s[44:47], s28 offen offset:3072 sc1
    s_add_u32 s28, s28, 163840
    buffer_load_dwordx4 v[80:83], v26, s[44:47], s28 offen offset:0 sc1
    buffer_load_dwordx4 v[84:87], v26, s[44:47], s28 offen offset:1024 sc1
    buffer_load_dwordx4 v[88:91], v26, s[44:47], s28 offen offset:2048 sc1
    buffer_load_dwordx4 v[92:95], v26, s[44:47], s28 offen offset:3072 sc1
    s_waitcnt vmcnt(37)
    ds_read_b64_tr_b16 v[32:33], v12 offset:0
    ds_read_b64_tr_b16 v[34:35], v12 offset:1024
    ds_read_b64_tr_b16 v[36:37], v13 offset:0
    ds_read_b64_tr_b16 v[38:39], v13 offset:1024
    s_add_u32 s35, s35, 163840
    s_waitcnt vmcnt(8)
    v_add3_u32 v10, v48, v49, s9
    v_add3_u32 v11, v56, v57, s9
    v_add3_u32 v10, v50, v51, v10
    v_add3_u32 v11, v58, v59, v11
    v_add3_u32 v10, v52, v53, v10
    v_add3_u32 v11, v60, v61, v11
    v_add3_u32 v10, v54, v55, v10
    v_add3_u32 v11, v62, v63, v11
    s_nop 1
    v_permlane16_swap_b32 v10, v11
    v_add_u32 v10, v10, v11
    v_cmp_ne_u32 vcc, v10, v2
    s_nop 0
    s_cbranch_vccnz LH_24
LH_26:
    s_mul_i32 s23, s3, 19584
    s_mov_b32 m0, s23
    s_waitcnt lgkmcnt(0)
    v_mfma_f32_32x32x16_bf16 v[112:127], v[48:51], v[32:35], 0
    ds_read_b64_tr_b16 v[40:41], v12 offset:2048
    ds_read_b64_tr_b16 v[42:43], v12 offset:3072
    s_add_u32 s28, s28, 163840
    buffer_load_dwordx4 v[96:99], v26, s[44:47], s28 offen offset:0 sc1
    v_mfma_f32_32x32x16_bf16 v[128:143], v[48:51], v[36:39], 0
    ds_read_b64_tr_b16 v[44:45], v13 offset:2048
    ds_read_b64_tr_b16 v[46:47], v13 offset:3072
    v_mfma_f32_32x32x16_bf16 v[144:159], v[56:59], v[32:35], 0
    ds_write_b128 v30, v[184:187] offset:0
    buffer_load_dwordx4 v[100:103], v26, s[44:47], s28 offen offset:1024 sc1
    v_mfma_f32_32x32x16_bf16 v[160:175], v[56:59], v[36:39], 0
    ds_write_b128 v30, v[188:191] offset:1024
    buffer_load_dwordx4 v[104:107], v26, s[44:47], s28 offen offset:2048 sc1
    s_waitcnt lgkmcnt(2)
    v_mfma_f32_32x32x16_bf16 v[112:127], v[52:55], v[40:43], v[112:127]
    ds_read_b64_tr_b16 v[32:33], v12 offset:4096
    ds_read_b64_tr_b16 v[34:35], v12 offset:5120
    buffer_load_dwordx4 v[108:111], v26, s[44:47], s28 offen offset:3072 sc1
    v_mfma_f32_32x32x16_bf16 v[128:143], v[52:55], v[44:47], v[128:143]
    ds_read_b64_tr_b16 v[36:37], v13 offset:4096
    ds_read_b64_tr_b16 v[38:39], v13 offset:5120
    s_waitcnt vmcnt(8)
    v_add3_u32 v10, v64, v65, s9
    v_add3_u32 v11, v72, v73, s9
    v_add3_u32 v10, v66, v67, v10
    v_mfma_f32_32x32x16_bf16 v[144:159], v[60:63], v[40:43], v[144:159]
    ds_write_b128 v30, v[192:195] offset:2048
    buffer_load_dwordx4 v[6:9], v28, s[44:47], s28 offen sc1
    v_add3_u32 v11, v74, v75, v11
    v_add3_u32 v10, v68, v69, v10
    v_add3_u32 v11, v76, v77, v11
    v_add3_u32 v10, v70, v71, v10
    v_add3_u32 v11, v78, v79, v11
    v_mfma_f32_32x32x16_bf16 v[160:175], v[60:63], v[44:47], v[160:175]
    ds_write_b128 v30, v[196:199] offset:3072
    v_permlane16_swap_b32 v10, v11
    v_add_u32 v10, v10, v11
    v_cmp_ne_u32 vcc, v10, v3
    s_add_u32 s35, s35, 163840
    s_cbranch_vccnz LH_28
LH_30:
    s_waitcnt lgkmcnt(2)
    v_mfma_f32_32x32x16_bf16 v[112:127], v[64:67], v[32:35], v[112:127]
    ds_read_b64_tr_b16 v[40:41], v12 offset:28928
    ds_read_b64_tr_b16 v[42:43], v12 offset:29952
    s_add_u32 s28, s28, 163840
    buffer_load_dwordx4 v[48:51], v26, s[44:47], s28 offen offset:0 sc1
    v_mfma_f32_32x32x16_bf16 v[128:143], v[64:67], v[36:39], v[128:143]
    ds_read_b64_tr_b16 v[44:45], v13 offset:28928
    ds_read_b64_tr_b16 v[46:47], v13 offset:29952
    v_mfma_f32_32x32x16_bf16 v[144:159], v[72:75], v[32:35], v[144:159]
    ds_write_b128 v30, v[200:203] offset:4096
    buffer_load_dwordx4 v[52:55], v26, s[44:47], s28 offen offset:1024 sc1
    v_mfma_f32_32x32x16_bf16 v[160:175], v[72:75], v[36:39], v[160:175]
    ds_write_b128 v30, v[204:207] offset:5120
    buffer_load_dwordx4 v[56:59], v26, s[44:47], s28 offen offset:2048 sc1
    s_waitcnt lgkmcnt(2)
    v_mfma_f32_32x32x16_bf16 v[112:127], v[68:71], v[40:43], v[112:127]
    ds_read_b64_tr_b16 v[32:33], v12 offset:30976
    ds_read_b64_tr_b16 v[34:35], v12 offset:32000
    buffer_load_dwordx4 v[60:63], v26, s[44:47], s28 offen offset:3072 sc1
    v_mfma_f32_32x32x16_bf16 v[128:143], v[68:71], v[44:47], v[128:143]
    ds_read_b64_tr_b16 v[36:37], v13 offset:30976
    ds_read_b64_tr_b16 v[38:39], v13 offset:32000
    s_waitcnt vmcnt(9)
    v_add3_u32 v10, v80, v81, s9
    v_add3_u32 v11, v88, v89, s9
    v_add3_u32 v10, v82, v83, v10
    v_mfma_f32_32x32x16_bf16 v[144:159], v[76:79], v[40:43], v[144:159]
    ds_write_b128 v30, v[208:211] offset:28928
    v_add3_u32 v11, v90, v91, v11
    v_add3_u32 v10, v84, v85, v10
    v_add3_u32 v11, v92, v93, v11
    v_add3_u32 v10, v86, v87, v10
    v_add3_u32 v11, v94, v95, v11
    v_mfma_f32_32x32x16_bf16 v[160:175], v[76:79], v[44:47], v[160:175]
    ds_write_b128 v30, v[212:215] offset:29952
    v_permlane16_swap_b32 v10, v11
    v_add_u32 v10, v10, v11
    v_cmp_ne_u32 vcc, v10, v4
    s_add_u32 s35, s35, 163840
    s_cbranch_vccnz LH_32
LH_34:
    s_waitcnt lgkmcnt(2)
    v_mfma_f32_32x32x16_bf16 v[112:127], v[80:83], v[32:35], v[112:127]
    ds_read_b64_tr_b16 v[40:41], v12 offset:33024
    ds_read_b64_tr_b16 v[42:43], v12 offset:34048
    s_add_u32 s28, s28, 163840
    buffer_load_dwordx4 v[64:67], v26, s[44:47], s28 offen offset:0 sc1
    v_mfma_f32_32x32x16_bf16 v[128:143], v[80:83], v[36:39], v[128:143]
    ds_read_b64_tr_b16 v[44:45], v13 offset:33024
    ds_read_b64_tr_b16 v[46:47], v13 offset:34048
    v_mfma_f32_32x32x16_bf16 v[144:159], v[88:91], v[32:35], v[144:159]
    ds_write_b128 v30, v[216:219] offset:30976
    buffer_load_dwordx4 v[68:71], v26, s[44:47], s28 offen offset:1024 sc1
    v_mfma_f32_32x32x16_bf16 v[160:175], v[88:91], v[36:39], v[160:175]
    ds_write_b128 v30, v[220:223] offset:32000
    buffer_load_dwordx4 v[72:75], v26, s[44:47], s28 offen offset:2048 sc1
    s_waitcnt lgkmcnt(2)
    v_mfma_f32_32x32x16_bf16 v[112:127], v[84:87], v[40:43], v[112:127]
    ds_read_b64_tr_b16 v[32:33], v12 offset:57856
    ds_read_b64_tr_b16 v[34:35], v12 offset:58880
    buffer_load_dwordx4 v[76:79], v26, s[44:47], s28 offen offset:3072 sc1
    v_mfma_f32_32x32x16_bf16 v[128:143], v[84:87], v[44:47], v[128:143]
    ds_read_b64_tr_b16 v[36:37], v13 offset:57856
    ds_read_b64_tr_b16 v[38:39], v13 offset:58880
    s_waitcnt vmcnt(8)
    v_add3_u32 v10, v96, v97, s9
    v_add3_u32 v11, v104, v105, s9
    v_add3_u32 v10, v98, v99, v10
    v_mfma_f32_32x32x16_bf16 v[144:159], v[92:95], v[40:43], v[144:159]
    ds_write_b128 v30, v[224:227] offset:33024
    v_add3_u32 v11, v106, v107, v11
    v_add3_u32 v10, v100, v101, v10
    v_add3_u32 v11, v108, v109, v11
    v_add3_u32 v10, v102, v103, v10
    v_add3_u32 v11, v110, v111, v11
    v_mfma_f32_32x32x16_bf16 v[160:175], v[92:95], v[44:47], v[160:175]
    ds_write_b128 v30, v[228:231] offset:34048
    v_permlane16_swap_b32 v10, v11
    v_add_u32 v10, v10, v11
    v_cmp_ne_u32 vcc, v10, v6
    s_add_u32 s35, s35, 163840
    s_cbranch_vccnz LH_36
LH_38:
    s_waitcnt lgkmcnt(2)
    v_mfma_f32_32x32x16_bf16 v[112:127], v[96:99], v[32:35], v[112:127]
    ds_read_b64_tr_b16 v[40:41], v12 offset:59904
    ds_read_b64_tr_b16 v[42:43], v12 offset:60928
    s_add_u32 s28, s28, 163840
    buffer_load_dwordx4 v[80:83], v26, s[44:47], s28 offen offset:0 sc1
    v_mfma_f32_32x32x16_bf16 v[128:143], v[96:99], v[36:39], v[128:143]
    ds_read_b64_tr_b16 v[44:45], v13 offset:59904
    ds_read_b64_tr_b16 v[46:47], v13 offset:60928
    v_mfma_f32_32x32x16_bf16 v[144:159], v[104:107], v[32:35], v[144:159]
    ds_write_b128 v30, v[232:235] offset:57856
    buffer_load_dwordx4 v[84:87], v26, s[44:47], s28 offen offset:1024 sc1
    v_mfma_f32_32x32x16_bf16 v[160:175], v[104:107], v[36:39], v[160:175]
    ds_write_b128 v30, v[236:239] offset:58880
    buffer_load_dwordx4 v[88:91], v26, s[44:47], s28 offen offset:2048 sc1
    s_waitcnt lgkmcnt(2)
    v_mfma_f32_32x32x16_bf16 v[112:127], v[100:103], v[40:43], v[112:127]
    ds_read_b64_tr_b16 v[32:33], v12 offset:61952
    ds_read_b64_tr_b16 v[34:35], v12 offset:62976
    buffer_load_dwordx4 v[92:95], v26, s[44:47], s28 offen offset:3072 sc1
    v_mfma_f32_32x32x16_bf16 v[128:143], v[100:103], v[44:47], v[128:143]
    ds_read_b64_tr_b16 v[36:37], v13 offset:61952
    ds_read_b64_tr_b16 v[38:39], v13 offset:62976
    s_waitcnt vmcnt(8)
    v_add3_u32 v10, v48, v49, s9
    v_add3_u32 v11, v56, v57, s9
    v_add3_u32 v10, v50, v51, v10
    v_mfma_f32_32x32x16_bf16 v[144:159], v[108:111], v[40:43], v[144:159]
    ds_write_b128 v30, v[240:243] offset:59904
    buffer_load_dwordx4 v[176:179], v28, s[44:47], s28 offen sc1
    v_add3_u32 v11, v58, v59, v11
    v_add3_u32 v10, v52, v53, v10
    v_add3_u32 v11, v60, v61, v11
    v_add3_u32 v10, v54, v55, v10
    v_add3_u32 v11, v62, v63, v11
    v_mfma_f32_32x32x16_bf16 v[160:175], v[108:111], v[44:47], v[160:175]
    ds_write_b128 v30, v[244:247] offset:60928
    v_permlane16_swap_b32 v10, v11
    v_add_u32 v10, v10, v11
    v_cmp_ne_u32 vcc, v10, v7
    s_add_u32 s35, s35, 163840
    s_cbranch_vccnz LH_40
LH_42:
    s_waitcnt lgkmcnt(2)
    v_mfma_f32_32x32x16_bf16 v[112:127], v[48:51], v[32:35], v[112:127]
    ds_read_b64_tr_b16 v[40:41], v14 offset:0
    ds_read_b64_tr_b16 v[42:43], v14 offset:1024
    s_add_u32 s28, s28, 163840
    buffer_load_dwordx4 v[96:99], v26, s[44:47], s28 offen offset:0 sc1
    v_mfma_f32_32x32x16_bf16 v[128:143], v[48:51], v[36:39], v[128:143]
    ds_read_b64_tr_b16 v[44:45], v15 offset:0
    ds_read_b64_tr_b16 v[46:47], v15 offset:1024
    v_mfma_f32_32x32x16_bf16 v[144:159], v[56:59], v[32:35], v[144:159]
    ds_write_b128 v30, v[248:251] offset:61952
    buffer_load_dwordx4 v[100:103], v26, s[44:47], s28 offen offset:1024 sc1
    v_mfma_f32_32x32x16_bf16 v[160:175], v[56:59], v[36:39], v[160:175]
    ds_write_b128 v30, v[252:255] offset:62976
    buffer_load_dwordx4 v[104:107], v26, s[44:47], s28 offen offset:2048 sc1
    s_waitcnt lgkmcnt(2)
    v_mfma_f32_32x32x16_bf16 v[112:127], v[52:55], v[40:43], v[112:127]
    ds_read_b64_tr_b16 v[32:33], v14 offset:2048
    ds_read_b64_tr_b16 v[34:35], v14 offset:3072
    buffer_load_dwordx4 v[108:111], v26, s[44:47], s28 offen offset:3072 sc1
    v_mfma_f32_32x32x16_bf16 v[128:143], v[52:55], v[44:47], v[128:143]
    ds_read_b64_tr_b16 v[36:37], v15 offset:2048
    ds_read_b64_tr_b16 v[38:39], v15 offset:3072
    s_waitcnt vmcnt(9)
    v_add3_u32 v10, v64, v65, s9
    v_add3_u32 v11, v72, v73, s9
    v_add3_u32 v10, v66, v67, v10
    v_mfma_f32_32x32x16_bf16 v[144:159], v[60:63], v[40:43], v[144:159]
    v_add3_u32 v11, v74, v75, v11
    v_add3_u32 v10, v68, v69, v10
    v_add3_u32 v11, v76, v77, v11
    v_add3_u32 v10, v70, v71, v10
    v_add3_u32 v11, v78, v79, v11
    v_mfma_f32_32x32x16_bf16 v[160:175], v[60:63], v[44:47], v[160:175]
    s_nop 0
    v_permlane16_swap_b32 v10, v11
    v_add_u32 v10, v10, v11
    v_cmp_ne_u32 vcc, v10, v8
    s_add_u32 s35, s35, 163840
    s_cbranch_vccnz LH_44
LH_46:
    s_waitcnt lgkmcnt(0)
    v_mfma_f32_32x32x16_bf16 v[112:127], v[64:67], v[32:35], v[112:127]
    ds_read_b64_tr_b16 v[40:41], v14 offset:4096
    ds_read_b64_tr_b16 v[42:43], v14 offset:5120
    s_add_u32 s28, s28, 163840
    buffer_load_dwordx4 v[48:51], v26, s[44:47], s28 offen offset:0 sc1
    v_mfma_f32_32x32x16_bf16 v[128:143], v[64:67], v[36:39], v[128:143]
    ds_read_b64_tr_b16 v[44:45], v15 offset:4096
    ds_read_b64_tr_b16 v[46:47], v15 offset:5120
    v_mfma_f32_32x32x16_bf16 v[144:159], v[72:75], v[32:35], v[144:159]
    buffer_load_dwordx4 v[52:55], v26, s[44:47], s28 offen offset:1024 sc1
    v_mfma_f32_32x32x16_bf16 v[160:175], v[72:75], v[36:39], v[160:175]
    buffer_load_dwordx4 v[56:59], v26, s[44:47], s28 offen offset:2048 sc1
    s_waitcnt lgkmcnt(0)
    v_mfma_f32_32x32x16_bf16 v[112:127], v[68:71], v[40:43], v[112:127]
    ds_read_b64_tr_b16 v[32:33], v14 offset:6144
    ds_read_b64_tr_b16 v[34:35], v14 offset:7168
    buffer_load_dwordx4 v[60:63], v26, s[44:47], s28 offen offset:3072 sc1
    v_mfma_f32_32x32x16_bf16 v[128:143], v[68:71], v[44:47], v[128:143]
    ds_read_b64_tr_b16 v[36:37], v15 offset:6144
    ds_read_b64_tr_b16 v[38:39], v15 offset:7168
    s_waitcnt vmcnt(8)
    v_add3_u32 v10, v80, v81, s9
    v_add3_u32 v11, v88, v89, s9
    v_add3_u32 v10, v82, v83, v10
    v_mfma_f32_32x32x16_bf16 v[144:159], v[76:79], v[40:43], v[144:159]
    v_add3_u32 v11, v90, v91, v11
    v_add3_u32 v10, v84, v85, v10
    v_add3_u32 v11, v92, v93, v11
    v_add3_u32 v10, v86, v87, v10
    v_add3_u32 v11, v94, v95, v11
    v_mfma_f32_32x32x16_bf16 v[160:175], v[76:79], v[44:47], v[160:175]
    s_nop 0
    v_permlane16_swap_b32 v10, v11
    v_add_u32 v10, v10, v11
    v_cmp_ne_u32 vcc, v10, v176
    s_add_u32 s35, s35, 163840
    s_cbranch_vccnz LH_48
LH_50:
    s_waitcnt lgkmcnt(0)
    v_mfma_f32_32x32x16_bf16 v[112:127], v[80:83], v[32:35], v[112:127]
    ds_read_b64_tr_b16 v[40:41], v12 offset:0
    ds_read_b64_tr_b16 v[42:43], v12 offset:1024
    s_add_u32 s28, s28, 163840
    buffer_load_dwordx4 v[64:67], v26, s[44:47], s28 offen offset:0 sc1
    v_mfma_f32_32x32x16_bf16 v[128:143], v[80:83], v[36:39], v[128:143]
    ds_read_b64_tr_b16 v[44:45], v13 offset:0
    ds_read_b64_tr_b16 v[46:47], v13 offset:1024
    v_mfma_f32_32x32x16_bf16 v[144:159], v[88:91], v[32:35], v[144:159]
    buffer_load_dwordx4 v[68:71], v26, s[44:47], s28 offen offset:1024 sc1
    v_mfma_f32_32x32x16_bf16 v[160:175], v[88:91], v[36:39], v[160:175]
    buffer_load_dwordx4 v[72:75], v26, s[44:47], s28 offen offset:2048 sc1
    v_mov_b32 v200, 0
    v_mov_b32 v201, 0
    v_mov_b32 v202, 0
    v_mov_b32 v203, 0
    v_mov_b32 v204, 0
    v_mov_b32 v205, 0
    v_mov_b32 v206, 0
    v_mov_b32 v207, 0
    v_mov_b32 v208, 0
    v_mov_b32 v209, 0
    v_mov_b32 v210, 0
    v_mov_b32 v211, 0
    v_mov_b32 v212, 0
    v_mov_b32 v213, 0
    v_mov_b32 v214, 0
    v_mov_b32 v215, 0
    s_waitcnt lgkmcnt(0)
    v_mfma_f32_32x32x16_bf16 v[112:127], v[84:87], v[40:43], v[112:127]
    ds_read_b64_tr_b16 v[32:33], v12 offset:2048
    ds_read_b64_tr_b16 v[34:35], v12 offset:3072
    buffer_load_dwordx4 v[76:79], v26, s[44:47], s28 offen offset:3072 sc1
    v_mfma_f32_32x32x16_bf16 v[128:143], v[84:87], v[44:47], v[128:143]
    ds_read_b64_tr_b16 v[36:37], v13 offset:2048
    ds_read_b64_tr_b16 v[38:39], v13 offset:3072
    s_waitcnt vmcnt(8)
    v_add3_u32 v10, v96, v97, s9
    v_add3_u32 v11, v104, v105, s9
    v_add3_u32 v10, v98, v99, v10
    v_mfma_f32_32x32x16_bf16 v[144:159], v[92:95], v[40:43], v[144:159]
    buffer_load_dwordx4 v[180:183], v28, s[44:47], s28 offen sc1
    v_add3_u32 v11, v106, v107, v11
    v_add3_u32 v10, v100, v101, v10
    v_add3_u32 v11, v108, v109, v11
    v_add3_u32 v10, v102, v103, v10
    v_add3_u32 v11, v110, v111, v11
    v_mfma_f32_32x32x16_bf16 v[160:175], v[92:95], v[44:47], v[160:175]
    s_nop 0
    v_permlane16_swap_b32 v10, v11
    v_add_u32 v10, v10, v11
    v_cmp_ne_u32 vcc, v10, v177
    s_add_u32 s35, s35, 163840
    s_cbranch_vccnz LH_52
LH_54:
    s_waitcnt lgkmcnt(0)
    v_mfma_f32_32x32x16_bf16 v[112:127], v[96:99], v[32:35], v[112:127]
    ds_read_b64_tr_b16 v[40:41], v12 offset:4096
    ds_read_b64_tr_b16 v[42:43], v12 offset:5120
    s_add_u32 s28, s28, 163840
    buffer_load_dwordx4 v[80:83], v26, s[44:47], s28 offen offset:0 sc1
    v_mfma_f32_32x32x16_bf16 v[128:143], v[96:99], v[36:39], v[128:143]
    ds_read_b64_tr_b16 v[44:45], v13 offset:4096
    ds_read_b64_tr_b16 v[46:47], v13 offset:5120
    v_mfma_f32_32x32x16_bf16 v[144:159], v[104:107], v[32:35], v[144:159]
    buffer_load_dwordx4 v[84:87], v26, s[44:47], s28 offen offset:1024 sc1
    v_mfma_f32_32x32x16_bf16 v[160:175], v[104:107], v[36:39], v[160:175]
    buffer_load_dwordx4 v[88:91], v26, s[44:47], s28 offen offset:2048 sc1
    s_waitcnt lgkmcnt(0)
    v_mfma_f32_32x32x16_bf16 v[112:127], v[100:103], v[40:43], v[112:127]
    ds_read_b64_tr_b16 v[32:33], v12 offset:28928
    ds_read_b64_tr_b16 v[34:35], v12 offset:29952
    buffer_load_dwordx4 v[92:95], v26, s[44:47], s28 offen offset:3072 sc1
    v_mfma_f32_32x32x16_bf16 v[128:143], v[100:103], v[44:47], v[128:143]
    ds_read_b64_tr_b16 v[36:37], v13 offset:28928
    ds_read_b64_tr_b16 v[38:39], v13 offset:29952
    s_waitcnt vmcnt(9)
    v_add3_u32 v10, v48, v49, s9
    v_add3_u32 v11, v56, v57, s9
    v_add3_u32 v10, v50, v51, v10
    v_mfma_f32_32x32x16_bf16 v[144:159], v[108:111], v[40:43], v[144:159]
    v_add3_u32 v11, v58, v59, v11
    v_add3_u32 v10, v52, v53, v10
    v_add3_u32 v11, v60, v61, v11
    v_add3_u32 v10, v54, v55, v10
    v_add3_u32 v11, v62, v63, v11
    v_mfma_f32_32x32x16_bf16 v[160:175], v[108:111], v[44:47], v[160:175]
    s_nop 0
    v_permlane16_swap_b32 v10, v11
    v_add_u32 v10, v10, v11
    v_cmp_ne_u32 vcc, v10, v178
    s_add_u32 s35, s35, 163840
    s_cbranch_vccnz LH_56
LH_58:
    s_waitcnt lgkmcnt(0)
    v_mfma_f32_32x32x16_bf16 v[112:127], v[48:51], v[32:35], v[112:127]
    ds_read_b64_tr_b16 v[40:41], v12 offset:30976
    ds_read_b64_tr_b16 v[42:43], v12 offset:32000
    v_mfma_f32_32x32x16_bf16 v[128:143], v[48:51], v[36:39], v[128:143]
    ds_read_b64_tr_b16 v[44:45], v13 offset:30976
    ds_read_b64_tr_b16 v[46:47], v13 offset:32000
    v_mfma_f32_32x32x16_bf16 v[144:159], v[56:59], v[32:35], v[144:159]
    v_mfma_f32_32x32x16_bf16 v[160:175], v[56:59], v[36:39], v[160:175]
    buffer_load_dwordx4 v[240:243], v24, s[48:51], s29 offen
    buffer_load_dwordx4 v[244:247], v24, s[48:51], s30 offen
    s_waitcnt lgkmcnt(0)
    v_mfma_f32_32x32x16_bf16 v[112:127], v[52:55], v[40:43], v[112:127]
    ds_read_b64_tr_b16 v[32:33], v12 offset:33024
    ds_read_b64_tr_b16 v[34:35], v12 offset:34048
    v_mfma_f32_32x32x16_bf16 v[128:143], v[52:55], v[44:47], v[128:143]
    ds_read_b64_tr_b16 v[36:37], v13 offset:33024
    ds_read_b64_tr_b16 v[38:39], v13 offset:34048
    s_waitcnt vmcnt(6)
    v_add3_u32 v10, v64, v65, s9
    v_add3_u32 v11, v72, v73, s9
    v_add3_u32 v10, v66, v67, v10
    v_mfma_f32_32x32x16_bf16 v[144:159], v[60:63], v[40:43], v[144:159]
    ds_read_b64_tr_b16 v[216:217], v12 offset:59904
    ds_read_b64_tr_b16 v[218:219], v12 offset:60928
    v_add3_u32 v11, v74, v75, v11
    v_add3_u32 v10, v68, v69, v10
    v_add3_u32 v11, v76, v77, v11
    v_add3_u32 v10, v70, v71, v10
    v_add3_u32 v11, v78, v79, v11
    v_mfma_f32_32x32x16_bf16 v[160:175], v[60:63], v[44:47], v[160:175]
    ds_read_b64_tr_b16 v[220:221], v13 offset:59904
    ds_read_b64_tr_b16 v[222:223], v13 offset:60928
    v_permlane16_swap_b32 v10, v11
    v_add_u32 v10, v10, v11
    v_cmp_ne_u32 vcc, v10, v180
    s_add_u32 s35, s35, 163840
    s_cbranch_vccnz LH_60
LH_62:
    buffer_load_dwordx4 v[232:235], v17, s[44:47], s34 offen sc1
    buffer_load_dwordx4 v[236:239], v17, s[44:47], s33 offen sc1
    buffer_load_dword v22, v21, s[44:47], s31 offen sc1
    buffer_load_dword v23, v21, s[44:47], s32 offen sc1
    s_waitcnt lgkmcnt(4)
    v_mfma_f32_32x32x16_bf16 v[112:127], v[64:67], v[32:35], v[112:127]
    ds_read_b64_tr_b16 v[40:41], v12 offset:57856
    ds_read_b64_tr_b16 v[42:43], v12 offset:58880
    v_mfma_f32_32x32x16_bf16 v[128:143], v[64:67], v[36:39], v[128:143]
    ds_read_b64_tr_b16 v[44:45], v13 offset:57856
    ds_read_b64_tr_b16 v[46:47], v13 offset:58880
    v_mfma_f32_32x32x16_bf16 v[144:159], v[72:75], v[32:35], v[144:159]
    ds_read_b64_tr_b16 v[224:225], v12 offset:61952
    ds_read_b64_tr_b16 v[226:227], v12 offset:62976
    v_mfma_f32_32x32x16_bf16 v[160:175], v[72:75], v[36:39], v[160:175]
    ds_read_b64_tr_b16 v[228:229], v13 offset:61952
    ds_read_b64_tr_b16 v[230:231], v13 offset:62976
    s_waitcnt lgkmcnt(4)
    v_mfma_f32_32x32x16_bf16 v[112:127], v[68:71], v[40:43], v[112:127]
    s_mov_b64 exec, 1
    ds_add_u32 v29, v31 offset:0
    s_mov_b64 exec, -1
    v_mfma_f32_32x32x16_bf16 v[128:143], v[68:71], v[44:47], v[128:143]
    s_waitcnt vmcnt(6)
    v_add3_u32 v10, v80, v81, s9
    v_add3_u32 v11, v88, v89, s9
    v_add3_u32 v10, v82, v83, v10
    v_mfma_f32_32x32x16_bf16 v[144:159], v[76:79], v[40:43], v[144:159]
    v_add3_u32 v11, v90, v91, v11
    v_add3_u32 v10, v84, v85, v10
    v_add3_u32 v11, v92, v93, v11
    v_add3_u32 v10, v86, v87, v10
    v_add3_u32 v11, v94, v95, v11
    v_mfma_f32_32x32x16_bf16 v[160:175], v[76:79], v[44:47], v[160:175]
    s_nop 0
    v_permlane16_swap_b32 v10, v11
    v_add_u32 v10, v10, v11
    v_cmp_ne_u32 vcc, v10, v181
    s_add_u32 s35, s35, 163840
    s_cbranch_vccnz LH_64
LH_66:
    s_waitcnt lgkmcnt(1)
    v_mfma_f32_32x32x16_bf16 v[112:127], v[80:83], v[216:219], v[112:127]
    v_mfma_f32_32x32x16_bf16 v[112:127], v[84:87], v[224:227], v[112:127]
    ds_read_b32 v1, v29 offset:0
    s_waitcnt lgkmcnt(0)
    v_readfirstlane_b32 s10, v1
    s_nop 0
    s_cmp_ge_u32 s10, 4
    s_cbranch_scc0 LW_68
LW_69:
    v_mfma_f32_32x32x16_bf16 v[128:143], v[80:83], v[220:223], v[128:143]
    v_mfma_f32_32x32x16_bf16 v[128:143], v[84:87], v[228:231], v[128:143]
    s_waitcnt vmcnt(4)
    v_lshlrev_b32 v184, 16, v240
    v_and_b32 v185, s13, v240
    v_lshlrev_b32 v186, 16, v241
    v_and_b32 v187, s13, v241
    v_lshlrev_b32 v188, 16, v242
    v_and_b32 v189, s13, v242
    v_lshlrev_b32 v190, 16, v243
    v_and_b32 v191, s13, v243
    v_lshlrev_b32 v192, 16, v244
    v_and_b32 v193, s13, v244
    v_lshlrev_b32 v194, 16, v245
    v_and_b32 v195, s13, v245
    v_lshlrev_b32 v196, 16, v246
    v_and_b32 v197, s13, v246
    v_lshlrev_b32 v198, 16, v247
    v_and_b32 v199, s13, v247
    v_mfma_f32_32x32x16_bf16 v[144:159], v[88:91], v[216:219], v[144:159]
    v_mfma_f32_32x32x16_bf16 v[144:159], v[92:95], v[224:227], v[144:159]
    ds_write_addtid_b32 v112 offset:0
    ds_write_addtid_b32 v113 offset:272
    ds_write_addtid_b32 v114 offset:640
    ds_write_addtid_b32 v115 offset:912
    ds_write_addtid_b32 v116 offset:2448
    ds_write_addtid_b32 v117 offset:2720
    ds_write_addtid_b32 v118 offset:3088
    ds_write_addtid_b32 v119 offset:3360
    v_mfma_f32_32x32x16_bf16 v[160:175], v[88:91], v[220:223], v[160:175]
    v_mfma_f32_32x32x16_bf16 v[160:175], v[92:95], v[228:231], v[160:175]
    ds_write_addtid_b32 v128 offset:1280
    ds_write_addtid_b32 v129 offset:1552
    ds_write_addtid_b32 v130 offset:1920
    ds_write_addtid_b32 v131 offset:2192
    ds_write_addtid_b32 v132 offset:3728
    ds_write_addtid_b32 v133 offset:4000
    ds_write_addtid_b32 v134 offset:4368
    ds_write_addtid_b32 v135 offset:4640
    ds_write_addtid_b32 v136 offset:6176
    ds_write_addtid_b32 v137 offset:6448
    ds_write_addtid_b32 v138 offset:6816
    ds_write_addtid_b32 v139 offset:7088
    ds_write_addtid_b32 v140 offset:8624
    ds_write_addtid_b32 v141 offset:8896
    ds_write_addtid_b32 v142 offset:9264
    ds_write_addtid_b32 v143 offset:9536
    ds_write_addtid_b32 v120 offset:4896
    ds_write_addtid_b32 v121 offset:5168
    ds_write_addtid_b32 v122 offset:5536
    ds_write_addtid_b32 v123 offset:5808
    ds_write_addtid_b32 v124 offset:7344
    ds_write_addtid_b32 v125 offset:7616
    ds_write_addtid_b32 v126 offset:7984
    ds_write_addtid_b32 v127 offset:8256
    ds_write_addtid_b32 v144 offset:9792
    ds_write_addtid_b32 v145 offset:10064
    ds_write_addtid_b32 v146 offset:10432
    ds_write_addtid_b32 v147 offset:10704
    ds_write_addtid_b32 v148 offset:12240
    ds_write_addtid_b32 v149 offset:12512
    ds_write_addtid_b32 v150 offset:12880
    ds_write_addtid_b32 v151 offset:13152
    ds_write_addtid_b32 v152 offset:14688
    ds_write_addtid_b32 v153 offset:14960
    ds_write_addtid_b32 v154 offset:15328
    ds_write_addtid_b32 v155 offset:15600
    ds_write_addtid_b32 v156 offset:17136
    ds_write_addtid_b32 v157 offset:17408
    ds_write_addtid_b32 v158 offset:17776
    ds_write_addtid_b32 v159 offset:18048
    s_waitcnt vmcnt(0)
    v_add3_u32 v10, v232, v233, s9
    v_add3_u32 v10, v234, v235, v10
    v_xor_b32 v10, v10, v22
    v_add3_u32 v11, v236, v237, s9
    v_add3_u32 v11, v238, v239, v11
    v_xor_b32 v11, v11, v23
    v_or_b32 v10, v10, v11
    v_cmp_ne_u32 vcc, 0, v10
    s_nop 0
    s_cbranch_vccnz LY_70
LY_72:
    ds_write_b128 v18, v[232:235]
    ds_write_b128 v18, v[236:239] offset:1216
    ds_write_addtid_b32 v160 offset:11072
    ds_write_addtid_b32 v161 offset:11344
    ds_write_addtid_b32 v162 offset:11712
    ds_write_addtid_b32 v163 offset:11984
    ds_write_addtid_b32 v164 offset:13520
    ds_write_addtid_b32 v165 offset:13792
    ds_write_addtid_b32 v166 offset:14160
    ds_write_addtid_b32 v167 offset:14432
    ds_write_addtid_b32 v168 offset:15968
    ds_write_addtid_b32 v169 offset:16240
    ds_write_addtid_b32 v170 offset:16608
    ds_write_addtid_b32 v171 offset:16880
    ds_write_addtid_b32 v172 offset:18416
    ds_write_addtid_b32 v173 offset:18688
    ds_write_addtid_b32 v174 offset:19056
    ds_write_addtid_b32 v175 offset:19328
    s_waitcnt lgkmcnt(0)
    s_barrier
    ds_read_b128 v[48:51], v20 offset:0
    ds_read_b128 v[52:55], v20 offset:16
    ds_read_b128 v[56:59], v20 offset:19584
    ds_read_b128 v[60:63], v20 offset:19600
    ds_read_b128 v[64:67], v20 offset:39168
    ds_read_b128 v[68:71], v20 offset:39184
    ds_read_b128 v[72:75], v20 offset:58752
    ds_read_b128 v[76:79], v20 offset:58768
    ds_read_u16_d16_hi v200, v19 offset:0
    ds_read_u16_d16_hi v201, v19 offset:144
    ds_read_u16_d16_hi v202, v19 offset:288
    ds_read_u16_d16_hi v203, v19 offset:432
    ds_read_u16_d16_hi v204, v19 offset:576
    ds_read_u16_d16_hi v205, v19 offset:720
    ds_read_u16_d16_hi v206, v19 offset:864
    ds_read_u16_d16_hi v207, v19 offset:1008
    s_waitcnt lgkmcnt(12)
    v_pk_add_f32 v[184:185], v[184:185], v[48:49]
    v_pk_add_f32 v[186:187], v[186:187], v[50:51]
    v_pk_add_f32 v[188:189], v[188:189], v[52:53]
    v_pk_add_f32 v[190:191], v[190:191], v[54:55]
    v_pk_add_f32 v[184:185], v[184:185], v[56:57]
    v_pk_add_f32 v[186:187], v[186:187], v[58:59]
    v_pk_add_f32 v[188:189], v[188:189], v[60:61]
    v_pk_add_f32 v[190:191], v[190:191], v[62:63]
    ds_read_b128 v[80:83], v20 offset:2448
    ds_read_b128 v[84:87], v20 offset:2464
    ds_read_b128 v[88:91], v20 offset:22032
    ds_read_b128 v[92:95], v20 offset:22048
    ds_read_b128 v[96:99], v20 offset:41616
    ds_read_b128 v[100:103], v20 offset:41632
    ds_read_b128 v[104:107], v20 offset:61200
    ds_read_b128 v[108:111], v20 offset:61216
    s_waitcnt lgkmcnt(15)
    v_pk_add_f32 v[184:185], v[184:185], v[64:65]
    v_pk_add_f32 v[186:187], v[186:187], v[66:67]
    v_pk_add_f32 v[188:189], v[188:189], v[68:69]
    v_pk_add_f32 v[190:191], v[190:191], v[70:71]
    v_pk_add_f32 v[184:185], v[184:185], v[72:73]
    v_pk_add_f32 v[186:187], v[186:187], v[74:75]
    v_pk_add_f32 v[188:189], v[188:189], v[76:77]
    v_pk_add_f32 v[190:191], v[190:191], v[78:79]
    ds_read_u16_d16_hi v208, v19 offset:16
    ds_read_u16_d16_hi v209, v19 offset:160
    ds_read_u16_d16_hi v210, v19 offset:304
    ds_read_u16_d16_hi v211, v19 offset:448
    ds_read_u16_d16_hi v212, v19 offset:592
    ds_read_u16_d16_hi v213, v19 offset:736
    ds_read_u16_d16_hi v214, v19 offset:880
    ds_read_u16_d16_hi v215, v19 offset:1024
    s_waitcnt lgkmcnt(15)
    v_pk_add_f32 v[184:185], v[184:185], v[200:201]
    v_pk_add_f32 v[186:187], v[186:187], v[202:203]
    v_pk_add_f32 v[188:189], v[188:189], v[204:205]
    v_pk_add_f32 v[190:191], v[190:191], v[206:207]
    v_cvt_pk_bf16_f32 v112, v184, v185
    v_cvt_pk_bf16_f32 v113, v186, v187
    v_cvt_pk_bf16_f32 v114, v188, v189
    v_cvt_pk_bf16_f32 v115, v190, v191
    buffer_store_dwordx4 v[112:115], v24, s[60:63], s29 offen sc1
    s_waitcnt lgkmcnt(14)
    v_pk_add_f32 v[192:193], v[192:193], v[80:81]
    v_pk_add_f32 v[194:195], v[194:195], v[82:83]
    v_pk_add_f32 v[196:197], v[196:197], v[84:85]
    v_pk_add_f32 v[198:199], v[198:199], v[86:87]
    s_waitcnt lgkmcnt(12)
    v_pk_add_f32 v[192:193], v[192:193], v[88:89]
    v_pk_add_f32 v[194:195], v[194:195], v[90:91]
    v_pk_add_f32 v[196:197], v[196:197], v[92:93]
    v_pk_add_f32 v[198:199], v[198:199], v[94:95]
    s_waitcnt lgkmcnt(10)
    v_pk_add_f32 v[192:193], v[192:193], v[96:97]
    v_pk_add_f32 v[194:195], v[194:195], v[98:99]
    v_pk_add_f32 v[196:197], v[196:197], v[100:101]
    v_pk_add_f32 v[198:199], v[198:199], v[102:103]
    s_waitcnt lgkmcnt(8)
    v_pk_add_f32 v[192:193], v[192:193], v[104:105]
    v_pk_add_f32 v[194:195], v[194:195], v[106:107]
    v_pk_add_f32 v[196:197], v[196:197], v[108:109]
    v_pk_add_f32 v[198:199], v[198:199], v[110:111]
    s_waitcnt lgkmcnt(0)
    v_pk_add_f32 v[192:193], v[192:193], v[208:209]
    v_pk_add_f32 v[194:195], v[194:195], v[210:211]
    v_pk_add_f32 v[196:197], v[196:197], v[212:213]
    v_pk_add_f32 v[198:199], v[198:199], v[214:215]
    v_cvt_pk_bf16_f32 v116, v192, v193
    v_cvt_pk_bf16_f32 v117, v194, v195
    v_cvt_pk_bf16_f32 v118, v196, v197
    v_cvt_pk_bf16_f32 v119, v198, v199
    buffer_store_dwordx4 v[116:119], v24, s[60:63], s30 offen sc1
    s_endpgm
L_S:
    s_mov_b32 s100, s16
    s_mov_b32 s101, s17
    s_add_u32 s44, s42, 0
    s_addc_u32 s45, s43, 0
    v_mov_b32 v30, 130052
    v_and_b32 v3, 7, v0
    v_and_b32 v44, 15, v0
    v_lshrrev_b32 v45, 4, v0
    s_lshr_b32 s56, s3, 1
    s_and_b32 s57, s3, 1
    s_mul_i32 s58, s56, 16640
    s_add_u32 s58, s58, 86784
    s_mul_i32 s59, s56, 4608
    s_add_u32 s59, s59, 120064
    s_add_u32 s10, s59, 480
    v_add_u32 v38, s10, v26
    v_lshlrev_b32 v39, 5, v44
    v_sub_u32 v39, s58, v39
    v_lshrrev_b32 v36, 1, v45
    v_xor_b32 v36, v36, v45
    v_and_b32 v36, 1, v36
    v_lshrrev_b32 v37, 1, v44
    v_lshl_or_b32 v36, v36, 3, v37
    v_and_b32 v37, 1, v0
    v_lshlrev_b32 v37, 4, v37
    v_mov_b32 v2, 0x3f80
    v_lshlrev_b32 v37, v37, v2
    s_lshl_b32 s10, s57, 11
    s_mul_i32 s11, s6, 8192
    s_mul_i32 s63, s56, 4096
    s_add_u32 s63, s63, s11
    s_add_u32 s63, s63, s10
    s_add_u32 s63, s63, 4980736
    s_sub_u32 s50, s63, 4980736
    s_lshr_b32 s50, s50, 2
    s_add_u32 s50, s50, 393216
    v_cmp_eq_u32 vcc, 0, v36
    s_nop 1
    v_cndmask_b32 v224, 0, v37, vcc
    v_cmp_eq_u32 vcc, 1, v36
    s_nop 1
    v_cndmask_b32 v225, 0, v37, vcc
    v_cmp_eq_u32 vcc, 2, v36
    s_nop 1
    v_cndmask_b32 v226, 0, v37, vcc
    v_cmp_eq_u32 vcc, 3, v36
    s_nop 1
    v_cndmask_b32 v227, 0, v37, vcc
    v_cmp_eq_u32 vcc, 4, v36
    s_nop 1
    v_cndmask_b32 v228, 0, v37, vcc
    v_cmp_eq_u32 vcc, 5, v36
    s_nop 1
    v_cndmask_b32 v229, 0, v37, vcc
    v_cmp_eq_u32 vcc, 6, v36
    s_nop 1
    v_cndmask_b32 v230, 0, v37, vcc
    v_cmp_eq_u32 vcc, 7, v36
    s_nop 1
    v_cndmask_b32 v231, 0, v37, vcc
    s_lshl_b32 s10, s56, 4
    s_mov_b32 s54, 0x3fb8aa3b
    s_waitcnt lgkmcnt(0)
    s_lshr_b32 s35, s35, s10
    s_lshl_b32 s35, s35, 16
    s_lshr_b32 s34, s34, s10
    s_lshl_b32 s34, s34, 16
    v_mov_b32 v20, s35
    v_mul_f32 v21, s54, v20
    v_fma_f32 v22, v20, s54, -v21
    v_fmac_f32 v22, 0x32a57060, v20
    v_exp_f32 v21, v21
    v_mul_f32 v22, 0x3f317218, v22
    v_fmac_f32 v21, v21, v22
    v_cvt_pk_bf16_f32 v21, v21, v21
    v_and_b32 v29, s13, v21
    s_lshr_b32 s10, s2, 3
    s_lshl_b32 s10, s10, 2
    s_add_u32 s10, s10, s3
    s_mul_i32 s10, s10, 11
    s_min_u32 s10, s10, 1365
    s_lshl_b32 s10, s10, 10
    s_and_b32 s7, s2, 4
    s_lshl_b32 s7, s7, 7
    s_add_u32 s10, s10, s7
    v_min_u32 v149, 43, v0
    v_lshrrev_b32 v148, 2, v149
    v_lshlrev_b32 v148, 10, v148
    v_and_b32 v149, 3, v149
    v_lshl_add_u32 v148, v149, 7, v148
    v_add_u32 v148, s10, v148
    s_and_b32 s11, s2, 3
    s_lshl_b32 s11, s11, 3
    s_lshr_b32 s11, 0x3020100, s11
    s_and_b32 s11, s11, 3
    s_lshl_b32 s11, s11, 7
    s_add_u32 s11, s11, s10
    s_add_u32 s4, s38, s11
    s_addc_u32 s5, s39, 0
    s_and_b32 s11, s2, 3
    s_lshl_b32 s11, s11, 3
    s_lshr_b32 s11, 0x30303, s11
    s_and_b32 s11, s11, 3
    s_lshl_b32 s11, s11, 7
    s_add_u32 s11, s11, s10
    s_add_u32 s14, s38, s11
    s_addc_u32 s15, s39, 0
    s_and_b32 s11, s2, 3
    s_lshl_b32 s11, s11, 3
    s_lshr_b32 s11, 0x1000201, s11
    s_and_b32 s11, s11, 3
    s_lshl_b32 s11, s11, 7
    s_add_u32 s11, s11, s10
    s_add_u32 s48, s38, s11
    s_addc_u32 s49, s39, 0
    s_and_b32 s11, s2, 3
    s_lshl_b32 s11, s11, 3
    s_lshr_b32 s11, 0x2010002, s11
    s_and_b32 s11, s11, 3
    s_lshl_b32 s11, s11, 7
    s_add_u32 s11, s11, s10
    s_add_u32 s52, s38, s11
    s_addc_u32 s53, s39, 0
    s_waitcnt vmcnt(4)
    s_setprio 3
    v_lshlrev_b32 v12, 16, v12
    v_lshlrev_b32 v13, 16, v13
    v_mul_f32 v20, v29, v12
    v_mul_f32 v21, v29, v13
    v_mul_f32 v20, s54, v20
    v_mul_f32 v21, 0x3e22f983, v21
    v_mul_f32 v12, 0x41800000, v20
    v_mul_f32 v13, 0x41800000, v21
    v_exp_f32 v12, v12
    v_fract_f32 v13, v13
    v_cos_f32 v24, v13
    v_sin_f32 v25, v13
    v_mul_f32 v24, v24, v12
    v_mul_f32 v25, v25, v12
    v_mov_b32 v90, 1.0
    v_mov_b32 v91, 0
    v_cvt_pk_bf16_f32 v116, v90, v24
    v_cvt_pk_bf16_f32 v124, v91, v25
    v_pk_mul_f32 v[90:91], v[24:25], v[24:25] op_sel_hi:[1,0]
    v_pk_fma_f32 v[90:91], v[24:25], v[24:25], v[90:91] op_sel:[1,1,0] op_sel_hi:[0,1,1] neg_lo:[0,1,0]
    v_pk_mul_f32 v[92:93], v[90:91], v[24:25] op_sel_hi:[1,0]
    v_pk_fma_f32 v[92:93], v[90:91], v[24:25], v[92:93] op_sel:[1,1,0] op_sel_hi:[0,1,1] neg_lo:[0,1,0]
    v_cvt_pk_bf16_f32 v117, v90, v92
    v_cvt_pk_bf16_f32 v125, v91, v93
    v_pk_mul_f32 v[90:91], v[92:93], v[24:25] op_sel_hi:[1,0]
    v_pk_fma_f32 v[90:91], v[92:93], v[24:25], v[90:91] op_sel:[1,1,0] op_sel_hi:[0,1,1] neg_lo:[0,1,0]
    v_pk_mul_f32 v[92:93], v[90:91], v[24:25] op_sel_hi:[1,0]
    v_pk_fma_f32 v[92:93], v[90:91], v[24:25], v[92:93] op_sel:[1,1,0] op_sel_hi:[0,1,1] neg_lo:[0,1,0]
    v_cvt_pk_bf16_f32 v118, v90, v92
    v_cvt_pk_bf16_f32 v126, v91, v93
    v_pk_mul_f32 v[90:91], v[92:93], v[24:25] op_sel_hi:[1,0]
    v_pk_fma_f32 v[90:91], v[92:93], v[24:25], v[90:91] op_sel:[1,1,0] op_sel_hi:[0,1,1] neg_lo:[0,1,0]
    v_pk_mul_f32 v[92:93], v[90:91], v[24:25] op_sel_hi:[1,0]
    v_pk_fma_f32 v[92:93], v[90:91], v[24:25], v[92:93] op_sel:[1,1,0] op_sel_hi:[0,1,1] neg_lo:[0,1,0]
    v_cvt_pk_bf16_f32 v119, v90, v92
    v_cvt_pk_bf16_f32 v127, v91, v93
    v_pk_mul_f32 v[90:91], v[92:93], v[24:25] op_sel_hi:[1,0]
    v_pk_fma_f32 v[90:91], v[92:93], v[24:25], v[90:91] op_sel:[1,1,0] op_sel_hi:[0,1,1] neg_lo:[0,1,0]
    v_pk_mul_f32 v[92:93], v[90:91], v[24:25] op_sel_hi:[1,0]
    v_pk_fma_f32 v[92:93], v[90:91], v[24:25], v[92:93] op_sel:[1,1,0] op_sel_hi:[0,1,1] neg_lo:[0,1,0]
    v_cvt_pk_bf16_f32 v120, v90, v92
    v_cvt_pk_bf16_f32 v128, v91, v93
    v_pk_mul_f32 v[90:91], v[92:93], v[24:25] op_sel_hi:[1,0]
    v_pk_fma_f32 v[90:91], v[92:93], v[24:25], v[90:91] op_sel:[1,1,0] op_sel_hi:[0,1,1] neg_lo:[0,1,0]
    v_pk_mul_f32 v[92:93], v[90:91], v[24:25] op_sel_hi:[1,0]
    v_pk_fma_f32 v[92:93], v[90:91], v[24:25], v[92:93] op_sel:[1,1,0] op_sel_hi:[0,1,1] neg_lo:[0,1,0]
    v_cvt_pk_bf16_f32 v121, v90, v92
    v_cvt_pk_bf16_f32 v129, v91, v93
    v_pk_mul_f32 v[90:91], v[92:93], v[24:25] op_sel_hi:[1,0]
    v_pk_fma_f32 v[90:91], v[92:93], v[24:25], v[90:91] op_sel:[1,1,0] op_sel_hi:[0,1,1] neg_lo:[0,1,0]
    v_pk_mul_f32 v[92:93], v[90:91], v[24:25] op_sel_hi:[1,0]
    v_pk_fma_f32 v[92:93], v[90:91], v[24:25], v[92:93] op_sel:[1,1,0] op_sel_hi:[0,1,1] neg_lo:[0,1,0]
    v_cvt_pk_bf16_f32 v122, v90, v92
    v_cvt_pk_bf16_f32 v130, v91, v93
    v_pk_mul_f32 v[90:91], v[92:93], v[24:25] op_sel_hi:[1,0]
    v_pk_fma_f32 v[90:91], v[92:93], v[24:25], v[90:91] op_sel:[1,1,0] op_sel_hi:[0,1,1] neg_lo:[0,1,0]
    v_pk_mul_f32 v[92:93], v[90:91], v[24:25] op_sel_hi:[1,0]
    v_pk_fma_f32 v[92:93], v[90:91], v[24:25], v[92:93] op_sel:[1,1,0] op_sel_hi:[0,1,1] neg_lo:[0,1,0]
    v_cvt_pk_bf16_f32 v123, v90, v92
    v_cvt_pk_bf16_f32 v131, v91, v93
    v_mfma_f32_32x32x16_bf16 v[176:191], v[116:119], v[224:227], 0
    v_mfma_f32_32x32x16_bf16 v[192:207], v[124:127], v[224:227], 0
    v_mfma_f32_32x32x16_bf16 v[176:191], v[120:123], v[228:231], v[176:191]
    v_mfma_f32_32x32x16_bf16 v[192:207], v[128:131], v[228:231], v[192:207]
    s_waitcnt vmcnt(0)
    v_lshlrev_b32 v14, 16, v14
    v_lshlrev_b32 v15, 16, v15
    v_lshlrev_b32 v16, 16, v16
    v_lshlrev_b32 v17, 16, v17
    v_mul_f32 v14, v29, v14
    v_mul_f32 v15, v29, v15
    v_mul_f32 v56, v16, v14
    v_mul_f32 v57, v17, v14
    v_fma_f32 v56, -v17, v15, v56
    v_fmac_f32 v57, v16, v15
    v_exp_f32 v12, v20
    v_fract_f32 v13, v21
    v_cos_f32 v22, v13
    v_sin_f32 v23, v13
    v_mul_f32 v22, v22, v12
    v_mul_f32 v23, v23, v12
    v_mul_f32 v12, 0x43800000, v20
    v_mul_f32 v13, 0x43800000, v21
    v_exp_f32 v12, v12
    v_fract_f32 v13, v13
    v_cos_f32 v48, v13
    v_sin_f32 v49, v13
    v_mul_f32 v48, v48, v12
    v_mul_f32 v49, v49, v12
    v_cvt_pk_bf16_f32 v208, v176, v177
    v_cvt_pk_bf16_f32 v209, v178, v179
    v_cvt_pk_bf16_f32 v210, v180, v181
    v_cvt_pk_bf16_f32 v211, v182, v183
    v_cvt_pk_bf16_f32 v212, v184, v185
    v_cvt_pk_bf16_f32 v213, v186, v187
    v_cvt_pk_bf16_f32 v214, v188, v189
    v_cvt_pk_bf16_f32 v215, v190, v191
    v_cvt_pk_bf16_f32 v216, v192, v193
    v_cvt_pk_bf16_f32 v217, v194, v195
    v_cvt_pk_bf16_f32 v218, v196, v197
    v_cvt_pk_bf16_f32 v219, v198, v199
    v_cvt_pk_bf16_f32 v220, v200, v201
    v_cvt_pk_bf16_f32 v221, v202, v203
    v_cvt_pk_bf16_f32 v222, v204, v205
    v_cvt_pk_bf16_f32 v223, v206, v207
    v_mul_f32 v58, v56, v22
    v_mul_f32 v59, v57, v22
    v_fma_f32 v58, -v57, v23, v58
    v_fmac_f32 v59, v56, v23
    v_mul_f32 v60, v58, v22
    v_mul_f32 v61, v59, v22
    v_fma_f32 v60, -v59, v23, v60
    v_fmac_f32 v61, v58, v23
    v_mul_f32 v62, v60, v22
    v_mul_f32 v63, v61, v22
    v_fma_f32 v62, -v61, v23, v62
    v_fmac_f32 v63, v60, v23
    v_mul_f32 v64, v62, v22
    v_mul_f32 v65, v63, v22
    v_fma_f32 v64, -v63, v23, v64
    v_fmac_f32 v65, v62, v23
    v_mul_f32 v66, v64, v22
    v_mul_f32 v67, v65, v22
    v_fma_f32 v66, -v65, v23, v66
    v_fmac_f32 v67, v64, v23
    v_mul_f32 v68, v66, v22
    v_mul_f32 v69, v67, v22
    v_fma_f32 v68, -v67, v23, v68
    v_fmac_f32 v69, v66, v23
    v_pk_mul_f32 v[70:71], v[68:69], v[22:23] op_sel_hi:[1,0]
    v_pk_fma_f32 v[70:71], v[68:69], v[22:23], v[70:71] op_sel:[1,1,0] op_sel_hi:[0,1,1] neg_lo:[0,1,0]
    v_pk_mul_f32 v[72:73], v[70:71], v[22:23] op_sel_hi:[1,0]
    v_pk_fma_f32 v[72:73], v[70:71], v[22:23], v[72:73] op_sel:[1,1,0] op_sel_hi:[0,1,1] neg_lo:[0,1,0]
    v_pk_mul_f32 v[74:75], v[72:73], v[22:23] op_sel_hi:[1,0]
    v_pk_fma_f32 v[74:75], v[72:73], v[22:23], v[74:75] op_sel:[1,1,0] op_sel_hi:[0,1,1] neg_lo:[0,1,0]
    v_pk_mul_f32 v[76:77], v[74:75], v[22:23] op_sel_hi:[1,0]
    v_pk_fma_f32 v[76:77], v[74:75], v[22:23], v[76:77] op_sel:[1,1,0] op_sel_hi:[0,1,1] neg_lo:[0,1,0]
    v_pk_mul_f32 v[78:79], v[76:77], v[22:23] op_sel_hi:[1,0]
    v_pk_fma_f32 v[78:79], v[76:77], v[22:23], v[78:79] op_sel:[1,1,0] op_sel_hi:[0,1,1] neg_lo:[0,1,0]
    v_pk_mul_f32 v[80:81], v[78:79], v[22:23] op_sel_hi:[1,0]
    v_pk_fma_f32 v[80:81], v[78:79], v[22:23], v[80:81] op_sel:[1,1,0] op_sel_hi:[0,1,1] neg_lo:[0,1,0]
    v_pk_mul_f32 v[82:83], v[80:81], v[22:23] op_sel_hi:[1,0]
    v_pk_fma_f32 v[82:83], v[80:81], v[22:23], v[82:83] op_sel:[1,1,0] op_sel_hi:[0,1,1] neg_lo:[0,1,0]
    v_pk_mul_f32 v[84:85], v[82:83], v[22:23] op_sel_hi:[1,0]
    v_pk_fma_f32 v[84:85], v[82:83], v[22:23], v[84:85] op_sel:[1,1,0] op_sel_hi:[0,1,1] neg_lo:[0,1,0]
    v_pk_mul_f32 v[86:87], v[84:85], v[22:23] op_sel_hi:[1,0]
    v_pk_fma_f32 v[86:87], v[84:85], v[22:23], v[86:87] op_sel:[1,1,0] op_sel_hi:[0,1,1] neg_lo:[0,1,0]
    v_pk_mul_f32 v[88:89], v[86:87], v[22:23] op_sel_hi:[1,0]
    v_pk_fma_f32 v[88:89], v[86:87], v[22:23], v[88:89] op_sel:[1,1,0] op_sel_hi:[0,1,1] neg_lo:[0,1,0]
    v_cvt_pk_bf16_f32 v116, v56, v58
    v_cvt_pk_bf16_f32 v124, -v57, -v59
    v_cvt_pk_bf16_f32 v117, v60, v62
    v_cvt_pk_bf16_f32 v125, -v61, -v63
    v_cvt_pk_bf16_f32 v118, v64, v66
    v_cvt_pk_bf16_f32 v126, -v65, -v67
    v_cvt_pk_bf16_f32 v119, v68, v70
    v_cvt_pk_bf16_f32 v127, -v69, -v71
    v_cvt_pk_bf16_f32 v120, v72, v74
    v_cvt_pk_bf16_f32 v128, -v73, -v75
    v_cvt_pk_bf16_f32 v121, v76, v78
    v_cvt_pk_bf16_f32 v129, -v77, -v79
    v_cvt_pk_bf16_f32 v122, v80, v82
    v_cvt_pk_bf16_f32 v130, -v81, -v83
    v_cvt_pk_bf16_f32 v123, v84, v86
    v_cvt_pk_bf16_f32 v131, -v85, -v87
    v_mfma_f32_32x32x16_bf16 v[176:191], v[116:119], v[224:227], 0
    v_mfma_f32_32x32x16_bf16 v[192:207], v[124:127], v[224:227], 0
    v_mfma_f32_32x32x16_bf16 v[176:191], v[120:123], v[228:231], v[176:191]
    v_mfma_f32_32x32x16_bf16 v[192:207], v[128:131], v[228:231], v[192:207]
    v_mul_f32 v90, v56, v48
    v_mul_f32 v91, v57, v48
    v_fma_f32 v90, -v57, v49, v90
    v_fmac_f32 v91, v56, v49
    v_mul_f32 v92, v60, v48
    v_mul_f32 v93, v61, v48
    v_fma_f32 v92, -v61, v49, v92
    v_fmac_f32 v93, v60, v49
    v_mul_f32 v94, v64, v48
    v_mul_f32 v95, v65, v48
    v_fma_f32 v94, -v65, v49, v94
    v_fmac_f32 v95, v64, v49
    v_mul_f32 v96, v68, v48
    v_mul_f32 v97, v69, v48
    v_fma_f32 v96, -v69, v49, v96
    v_fmac_f32 v97, v68, v49
    v_mul_f32 v98, v72, v48
    v_mul_f32 v99, v73, v48
    v_fma_f32 v98, -v73, v49, v98
    v_fmac_f32 v99, v72, v49
    v_mul_f32 v100, v76, v48
    v_mul_f32 v101, v77, v48
    v_fma_f32 v100, -v77, v49, v100
    v_fmac_f32 v101, v76, v49
    v_mul_f32 v102, v80, v48
    v_mul_f32 v103, v81, v48
    v_fma_f32 v102, -v81, v49, v102
    v_fmac_f32 v103, v80, v49
    v_pk_mul_f32 v[104:105], v[84:85], v[48:49] op_sel_hi:[1,0]
    v_pk_fma_f32 v[104:105], v[84:85], v[48:49], v[104:105] op_sel:[1,1,0] op_sel_hi:[0,1,1] neg_lo:[0,1,0]
    v_pk_mul_f32 v[106:107], v[88:89], v[48:49] op_sel_hi:[1,0]
    v_pk_fma_f32 v[106:107], v[88:89], v[48:49], v[106:107] op_sel:[1,1,0] op_sel_hi:[0,1,1] neg_lo:[0,1,0]
    v_pk_mul_f32 v[50:51], v[48:49], v[48:49] op_sel_hi:[1,0]
    v_pk_fma_f32 v[50:51], v[48:49], v[48:49], v[50:51] op_sel:[1,1,0] op_sel_hi:[0,1,1] neg_lo:[0,1,0]
    v_pk_mul_f32 v[52:53], v[50:51], v[48:49] op_sel_hi:[1,0]
    v_pk_fma_f32 v[52:53], v[50:51], v[48:49], v[52:53] op_sel:[1,1,0] op_sel_hi:[0,1,1] neg_lo:[0,1,0]
    v_pk_mul_f32 v[54:55], v[50:51], v[50:51] op_sel_hi:[1,0]
    v_pk_fma_f32 v[54:55], v[50:51], v[50:51], v[54:55] op_sel:[1,1,0] op_sel_hi:[0,1,1] neg_lo:[0,1,0]
    v_pk_mul_f32 v[4:5], v[54:55], v[48:49] op_sel_hi:[1,0]
    v_pk_fma_f32 v[4:5], v[54:55], v[48:49], v[4:5] op_sel:[1,1,0] op_sel_hi:[0,1,1] neg_lo:[0,1,0]
    v_pk_mul_f32 v[6:7], v[54:55], v[50:51] op_sel_hi:[1,0]
    v_pk_fma_f32 v[6:7], v[54:55], v[50:51], v[6:7] op_sel:[1,1,0] op_sel_hi:[0,1,1] neg_lo:[0,1,0]
    v_pk_mul_f32 v[8:9], v[54:55], v[52:53] op_sel_hi:[1,0]
    v_pk_fma_f32 v[8:9], v[54:55], v[52:53], v[8:9] op_sel:[1,1,0] op_sel_hi:[0,1,1] neg_lo:[0,1,0]
    v_pk_mul_f32 v[148:149], v[72:73], v[54:55] op_sel_hi:[1,0]
    v_pk_fma_f32 v[148:149], v[72:73], v[54:55], v[148:149] op_sel:[1,1,0] op_sel_hi:[0,1,1] neg_lo:[0,1,0]
    v_pk_mul_f32 v[150:151], v[72:73], v[4:5] op_sel_hi:[1,0]
    v_pk_fma_f32 v[150:151], v[72:73], v[4:5], v[150:151] op_sel:[1,1,0] op_sel_hi:[0,1,1] neg_lo:[0,1,0]
    v_pk_mul_f32 v[152:153], v[72:73], v[6:7] op_sel_hi:[1,0]
    v_pk_fma_f32 v[152:153], v[72:73], v[6:7], v[152:153] op_sel:[1,1,0] op_sel_hi:[0,1,1] neg_lo:[0,1,0]
    v_pk_mul_f32 v[154:155], v[72:73], v[8:9] op_sel_hi:[1,0]
    v_pk_fma_f32 v[154:155], v[72:73], v[8:9], v[154:155] op_sel:[1,1,0] op_sel_hi:[0,1,1] neg_lo:[0,1,0]
    v_cvt_pk_bf16_f32 v132, v176, v177
    v_cvt_pk_bf16_f32 v133, v178, v179
    v_cvt_pk_bf16_f32 v134, v180, v181
    v_cvt_pk_bf16_f32 v135, v182, v183
    v_cvt_pk_bf16_f32 v136, v184, v185
    v_cvt_pk_bf16_f32 v137, v186, v187
    v_cvt_pk_bf16_f32 v138, v188, v189
    v_cvt_pk_bf16_f32 v139, v190, v191
    v_cvt_pk_bf16_f32 v140, v192, v193
    v_cvt_pk_bf16_f32 v141, v194, v195
    v_cvt_pk_bf16_f32 v142, v196, v197
    v_cvt_pk_bf16_f32 v143, v198, v199
    v_cvt_pk_bf16_f32 v144, v200, v201
    v_cvt_pk_bf16_f32 v145, v202, v203
    v_cvt_pk_bf16_f32 v146, v204, v205
    v_cvt_pk_bf16_f32 v147, v206, v207
    v_mfma_f32_16x16x32_bf16 v[160:163], v[132:135], v[208:211], 0
    v_mfma_f32_16x16x32_bf16 v[160:163], v[136:139], v[212:215], v[160:163]
    v_mfma_f32_16x16x32_bf16 v[160:163], v[140:143], v[216:219], v[160:163]
    v_mfma_f32_16x16x32_bf16 v[160:163], v[144:147], v[220:223], v[160:163]
    v_cvt_pk_bf16_f32 v116, v90, v92
    v_cvt_pk_bf16_f32 v124, -v91, -v93
    v_cvt_pk_bf16_f32 v117, v94, v148
    v_cvt_pk_bf16_f32 v125, -v95, -v149
    v_cvt_pk_bf16_f32 v118, v94, v96
    v_cvt_pk_bf16_f32 v126, -v95, -v97
    v_cvt_pk_bf16_f32 v119, v98, v150
    v_cvt_pk_bf16_f32 v127, -v99, -v151
    v_cvt_pk_bf16_f32 v120, v98, v100
    v_cvt_pk_bf16_f32 v128, -v99, -v101
    v_cvt_pk_bf16_f32 v121, v102, v152
    v_cvt_pk_bf16_f32 v129, -v103, -v153
    v_cvt_pk_bf16_f32 v122, v102, v104
    v_cvt_pk_bf16_f32 v130, -v103, -v105
    v_cvt_pk_bf16_f32 v123, v106, v154
    v_cvt_pk_bf16_f32 v131, -v107, -v155
    v_mfma_f32_32x32x16_bf16 v[176:191], v[116:119], v[224:227], 0
    v_mfma_f32_32x32x16_bf16 v[192:207], v[124:127], v[224:227], 0
    v_mfma_f32_32x32x16_bf16 v[176:191], v[120:123], v[228:231], v[176:191]
    v_mfma_f32_32x32x16_bf16 v[192:207], v[128:131], v[228:231], v[192:207]
    v_mul_f32 v90, v56, v50
    v_mul_f32 v91, v57, v50
    v_fma_f32 v90, -v57, v51, v90
    v_fmac_f32 v91, v56, v51
    v_mul_f32 v92, v64, v50
    v_mul_f32 v93, v65, v50
    v_fma_f32 v92, -v65, v51, v92
    v_fmac_f32 v93, v64, v51
    v_mul_f32 v94, v72, v50
    v_mul_f32 v95, v73, v50
    v_fma_f32 v94, -v73, v51, v94
    v_fmac_f32 v95, v72, v51
    v_mul_f32 v96, v80, v50
    v_mul_f32 v97, v81, v50
    v_fma_f32 v96, -v81, v51, v96
    v_fmac_f32 v97, v80, v51
    v_mul_f32 v98, v88, v50
    v_mul_f32 v99, v89, v50
    v_fma_f32 v98, -v89, v51, v98
    v_fmac_f32 v99, v88, v51
    v_mul_f32 v100, v56, v52
    v_mul_f32 v101, v57, v52
    v_fma_f32 v100, -v57, v53, v100
    v_fmac_f32 v101, v56, v53
    v_mul_f32 v102, v64, v52
    v_mul_f32 v103, v65, v52
    v_fma_f32 v102, -v65, v53, v102
    v_fmac_f32 v103, v64, v53
    v_pk_mul_f32 v[104:105], v[72:73], v[52:53] op_sel_hi:[1,0]
    v_pk_fma_f32 v[104:105], v[72:73], v[52:53], v[104:105] op_sel:[1,1,0] op_sel_hi:[0,1,1] neg_lo:[0,1,0]
    v_pk_mul_f32 v[106:107], v[80:81], v[52:53] op_sel_hi:[1,0]
    v_pk_fma_f32 v[106:107], v[80:81], v[52:53], v[106:107] op_sel:[1,1,0] op_sel_hi:[0,1,1] neg_lo:[0,1,0]
    v_pk_mul_f32 v[108:109], v[88:89], v[52:53] op_sel_hi:[1,0]
    v_pk_fma_f32 v[108:109], v[88:89], v[52:53], v[108:109] op_sel:[1,1,0] op_sel_hi:[0,1,1] neg_lo:[0,1,0]
    v_pk_mul_f32 v[148:149], v[88:89], v[54:55] op_sel_hi:[1,0]
    v_pk_fma_f32 v[148:149], v[88:89], v[54:55], v[148:149] op_sel:[1,1,0] op_sel_hi:[0,1,1] neg_lo:[0,1,0]
    v_pk_mul_f32 v[150:151], v[88:89], v[4:5] op_sel_hi:[1,0]
    v_pk_fma_f32 v[150:151], v[88:89], v[4:5], v[150:151] op_sel:[1,1,0] op_sel_hi:[0,1,1] neg_lo:[0,1,0]
    v_pk_mul_f32 v[152:153], v[88:89], v[6:7] op_sel_hi:[1,0]
    v_pk_fma_f32 v[152:153], v[88:89], v[6:7], v[152:153] op_sel:[1,1,0] op_sel_hi:[0,1,1] neg_lo:[0,1,0]
    v_pk_mul_f32 v[154:155], v[88:89], v[8:9] op_sel_hi:[1,0]
    v_pk_fma_f32 v[154:155], v[88:89], v[8:9], v[154:155] op_sel:[1,1,0] op_sel_hi:[0,1,1] neg_lo:[0,1,0]
    v_cvt_pk_bf16_f32 v132, v176, v177
    v_cvt_pk_bf16_f32 v133, v178, v179
    v_cvt_pk_bf16_f32 v134, v180, v181
    v_cvt_pk_bf16_f32 v135, v182, v183
    v_cvt_pk_bf16_f32 v136, v184, v185
    v_cvt_pk_bf16_f32 v137, v186, v187
    v_cvt_pk_bf16_f32 v138, v188, v189
    v_cvt_pk_bf16_f32 v139, v190, v191
    v_cvt_pk_bf16_f32 v140, v192, v193
    v_cvt_pk_bf16_f32 v141, v194, v195
    v_cvt_pk_bf16_f32 v142, v196, v197
    v_cvt_pk_bf16_f32 v143, v198, v199
    v_cvt_pk_bf16_f32 v144, v200, v201
    v_cvt_pk_bf16_f32 v145, v202, v203
    v_cvt_pk_bf16_f32 v146, v204, v205
    v_cvt_pk_bf16_f32 v147, v206, v207
    v_mfma_f32_16x16x32_bf16 v[164:167], v[132:135], v[208:211], 0
    v_mfma_f32_16x16x32_bf16 v[164:167], v[136:139], v[212:215], v[164:167]
    v_mfma_f32_16x16x32_bf16 v[164:167], v[140:143], v[216:219], v[164:167]
    v_mfma_f32_16x16x32_bf16 v[164:167], v[144:147], v[220:223], v[164:167]
    v_cvt_pk_bf16_f32 v116, v90, v92
    v_cvt_pk_bf16_f32 v124, -v91, -v93
    v_cvt_pk_bf16_f32 v117, v94, v148
    v_cvt_pk_bf16_f32 v125, -v95, -v149
    v_cvt_pk_bf16_f32 v118, v94, v96
    v_cvt_pk_bf16_f32 v126, -v95, -v97
    v_cvt_pk_bf16_f32 v119, v98, v150
    v_cvt_pk_bf16_f32 v127, -v99, -v151
    v_cvt_pk_bf16_f32 v120, v100, v102
    v_cvt_pk_bf16_f32 v128, -v101, -v103
    v_cvt_pk_bf16_f32 v121, v104, v152
    v_cvt_pk_bf16_f32 v129, -v105, -v153
    v_cvt_pk_bf16_f32 v122, v104, v106
    v_cvt_pk_bf16_f32 v130, -v105, -v107
    v_cvt_pk_bf16_f32 v123, v108, v154
    v_cvt_pk_bf16_f32 v131, -v109, -v155
    v_mfma_f32_32x32x16_bf16 v[176:191], v[116:119], v[224:227], 0
    v_mfma_f32_32x32x16_bf16 v[192:207], v[124:127], v[224:227], 0
    v_mfma_f32_32x32x16_bf16 v[176:191], v[120:123], v[228:231], v[176:191]
    v_mfma_f32_32x32x16_bf16 v[192:207], v[128:131], v[228:231], v[192:207]
    s_nop 10
    v_cvt_pk_bf16_f32 v132, v176, v177
    v_cvt_pk_bf16_f32 v133, v178, v179
    v_cvt_pk_bf16_f32 v134, v180, v181
    v_cvt_pk_bf16_f32 v135, v182, v183
    v_cvt_pk_bf16_f32 v136, v184, v185
    v_cvt_pk_bf16_f32 v137, v186, v187
    v_cvt_pk_bf16_f32 v138, v188, v189
    v_cvt_pk_bf16_f32 v139, v190, v191
    v_cvt_pk_bf16_f32 v140, v192, v193
    v_cvt_pk_bf16_f32 v141, v194, v195
    v_cvt_pk_bf16_f32 v142, v196, v197
    v_cvt_pk_bf16_f32 v143, v198, v199
    v_cvt_pk_bf16_f32 v144, v200, v201
    v_cvt_pk_bf16_f32 v145, v202, v203
    v_cvt_pk_bf16_f32 v146, v204, v205
    v_cvt_pk_bf16_f32 v147, v206, v207
    v_mfma_f32_16x16x32_bf16 v[168:171], v[132:135], v[208:211], 0
    v_mfma_f32_16x16x32_bf16 v[168:171], v[136:139], v[212:215], v[168:171]
    v_mfma_f32_16x16x32_bf16 v[168:171], v[140:143], v[216:219], v[168:171]
    v_mfma_f32_16x16x32_bf16 v[168:171], v[144:147], v[220:223], v[168:171]
    s_setprio 0
    s_load_dwordx2 s[16:17], s[4:5], 60
    s_load_dwordx2 s[18:19], s[4:5], 1084
    s_load_dwordx2 s[20:21], s[4:5], 2108
    s_load_dwordx2 s[22:23], s[4:5], 3132
    s_load_dwordx2 s[24:25], s[4:5], 4156
    s_load_dwordx2 s[26:27], s[4:5], 5180
    s_load_dwordx2 s[28:29], s[4:5], 6204
    s_load_dwordx2 s[30:31], s[4:5], 7228
    s_load_dwordx2 s[16:17], s[4:5], 8252
    s_load_dwordx2 s[18:19], s[4:5], 9276
    s_load_dwordx2 s[20:21], s[4:5], 10300
    s_load_dwordx2 s[22:23], s[14:15], 60
    s_load_dwordx2 s[24:25], s[14:15], 1084
    s_load_dwordx2 s[26:27], s[14:15], 2108
    s_load_dwordx2 s[28:29], s[14:15], 3132
    s_load_dwordx2 s[30:31], s[14:15], 4156
    s_load_dwordx2 s[16:17], s[14:15], 5180
    s_load_dwordx2 s[18:19], s[14:15], 6204
    s_load_dwordx2 s[20:21], s[14:15], 7228
    s_load_dwordx2 s[22:23], s[14:15], 8252
    s_load_dwordx2 s[24:25], s[14:15], 9276
    s_load_dwordx2 s[26:27], s[14:15], 10300
    s_lshl_b32 s10, s3, 9
    s_add_u32 s60, s10, 262144
    v_lshlrev_b32 v35, 2, v0
    v_lshlrev_b32 v241, 3, v0
    v_lshrrev_b32 v32, 1, v0
    v_and_b32 v33, 1, v0
    v_mul_u32_u24 v34, 8192, v32
    v_lshl_add_u32 v34, v33, 4, v34
    v_mul_u32_u24 v47, 4608, v33
    v_lshl_add_u32 v47, v32, 4, v47
    v_add_u32 v47, 120064, v47
    v_mov_b32 v48, 0
    v_mov_b32 v49, 0
    v_mov_b32 v50, 0
    v_mov_b32 v51, 0
    s_mov_b32 exec_hi, 0x0fffffff
    ds_write_b128 v47, v[48:51]
    s_mov_b64 exec, -1
    s_lshl_b32 s10, s3, 10
    v_add_u32 v47, s10, v47
    s_mul_i32 s61, s3, 524288
    s_lshl_b32 s10, s6, 5
    s_add_u32 s61, s61, s10
    s_add_u32 s61, s61, 2621440
    s_add_u32 s62, s61, 262144
    v_bfe_u32 v43, v0, 3, 2
    v_mul_u32_u24 v46, 4160, v43
    v_min_u32 v42, 1, v43
    v_lshl_add_u32 v46, v42, 3, v46
    v_lshrrev_b32 v43, 1, v43
    v_sub_u32 v43, v3, v43
    v_lshl_add_u32 v46, v43, 2, v46
    v_add_u32 v46, s58, v46
    ds_write_b32 v46, v27 offset:4112
    v_lshlrev_b32 v40, 3, v45
    v_sub_u32 v40, v39, v40
    v_lshrrev_b32 v41, 1, v45
    v_lshlrev_b32 v41, 9, v41
    v_and_b32 v42, 16, v0
    v_add_u32 v41, v41, v42
    v_sub_u32 v41, v39, v41
    v_lshlrev_b32 v46, 9, v45
    v_sub_u32 v46, v39, v46
    v_add_u32 v42, 11916, v40
    v_add_u32 v43, 7756, v40
    v_sub_u32 v232, 3, v44
    v_and_b32 v232, 3, v232
    v_mul_u32_u24 v233, 4158, v232
    v_min_u32 v232, 1, v232
    v_lshl_add_u32 v233, v232, 3, v233
    v_lshl_add_u32 v233, v45, 4, v233
    v_lshlrev_b32 v234, 1, v44
    v_sub_u32 v233, v233, v234
    s_lshl_b32 s10, s57, 8
    s_sub_u32 s11, s58, s10
    s_add_u32 s11, s11, 302
    v_add_u32 v232, s11, v233
    v_lshlrev_b32 v233, 5, v44
    v_lshl_add_u32 v233, v45, 4, v233
    s_sub_u32 s11, s59, s10
    s_add_u32 s11, s11, 256
    v_add_u32 v233, s11, v233
    v_bfe_u32 v234, v0, 1, 2
    v_xor_b32 v234, v234, v45
    v_lshlrev_b32 v234, 4, v234
    v_lshl_add_u32 v234, v44, 6, v234
    s_lshl_b32 s10, s57, 13
    s_add_u32 s10, s10, s58
    v_add_u32 v234, s10, v234
    s_lshl_b32 s10, s57, 12
    s_add_u32 s10, s10, s58
    v_lshlrev_b32 v235, 5, v0
    v_and_b32 v236, 12, v0
    v_lshlrev_b32 v236, 2, v236
    v_xor_b32 v235, v235, v236
    v_xor_b32 v236, 16, v235
    v_add_u32 v235, s10, v235
    v_add_u32 v236, s10, v236
    s_lshl_b32 s10, s57, 11
    s_add_u32 s11, s10, s59
    v_add_u32 v237, s11, v26
    s_lshl_b32 s10, s3, 2
    s_add_u32 s10, s10, 130064
    v_mov_b32 v238, s10
    v_lshrrev_b32 v239, 3, v0
    v_lshlrev_b32 v239, 10, v239
    v_lshl_or_b32 v239, v3, 4, v239
    v_and_b32 v240, 16, v0
    v_lshlrev_b32 v240, 2, v240
    v_xor_b32 v239, v239, v240
    v_add_u32 v240, 7168, v239
    v_lshlrev_b32 v242, 3, v45
    v_sub_u32 v242, v232, v242
    s_lshl_b32 s10, s57, 9
    s_sub_u32 s10, s10, 264
    v_add_u32 v242, s10, v242
    s_mul_i32 s10, s57, 272
    s_add_u32 s10, s10, 176
    v_add_u32 v243, s10, v233
    v_add_u32 v248, 1728, v232
    v_mov_b32 v4, s59
    s_cmp_eq_u32 s57, 0
    s_cselect_b64 vcc, -1, 0
    v_cndmask_b32 v248, v4, v248, vcc
    v_lshlrev_b32 v249, 1, v0
    v_sub_u32 v249, s58, v249
    v_and_b32 v4, 3, v0
    v_mul_u32_u24 v250, 4160, v4
    v_add_u32 v250, s58, v250
    v_lshrrev_b32 v5, 2, v0
    v_min_u32 v6, 3, v5
    v_lshlrev_b32 v6, 4, v6
    v_sub_u32 v251, v250, v6
    v_and_b32 v6, 1, v5
    v_lshl_add_u32 v250, v6, 8, v250
    v_lshrrev_b32 v6, 3, v0
    v_min_u32 v6, 5, v6
    v_lshl_add_u32 v250, v6, 4, v250
    s_sub_u32 s10, 4, s57
    s_lshl_b32 s11, s10, 1
    s_sub_u32 s10, s10, 8
    v_lshlrev_b32 v4, 3, v45
    v_sub_u32 v4, v4, v44
    v_add_u32 v4, s10, v4
    v_mov_b32 v7, 0x3f80
    v_mov_b32 v8, 1.0
    v_add_u32 v5, 16, v0
    v_add_u32 v6, 1, v44
    v_cmp_gt_u32 vcc, 64, v5
    s_nop 1
    v_cndmask_b32 v252, v6, v5, vcc
    v_lshlrev_b32 v252, 2, v252
    v_add_u32 v5, 0, v4
    v_add_u32 v6, 1, v4
    v_cmp_ge_u32 vcc, s11, v5
    s_nop 1
    v_cndmask_b32 v5, 0, v7, vcc
    v_cmp_ge_u32 vcc, s11, v6
    s_nop 1
    v_cndmask_b32 v6, 0, v8, vcc
    v_or_b32 v244, v5, v6
    v_add_u32 v5, 2, v4
    v_add_u32 v6, 3, v4
    v_cmp_ge_u32 vcc, s11, v5
    s_nop 1
    v_cndmask_b32 v5, 0, v7, vcc
    v_cmp_ge_u32 vcc, s11, v6
    s_nop 1
    v_cndmask_b32 v6, 0, v8, vcc
    v_or_b32 v245, v5, v6
    v_add_u32 v5, 4, v4
    v_add_u32 v6, 5, v4
    v_cmp_ge_u32 vcc, s11, v5
    s_nop 1
    v_cndmask_b32 v5, 0, v7, vcc
    v_cmp_ge_u32 vcc, s11, v6
    s_nop 1
    v_cndmask_b32 v6, 0, v8, vcc
    v_or_b32 v246, v5, v6
    v_add_u32 v5, 6, v4
    v_add_u32 v6, 7, v4
    v_cmp_ge_u32 vcc, s11, v5
    s_nop 1
    v_cndmask_b32 v5, 0, v7, vcc
    v_cmp_ge_u32 vcc, s11, v6
    s_nop 1
    v_cndmask_b32 v6, 0, v8, vcc
    v_or_b32 v247, v5, v6
    ds_read_b32 v24, v238 offset:224
    s_waitcnt lgkmcnt(0)
    v_readfirstlane_b32 s10, v24
    s_nop 0
    s_cmp_ge_u32 s10, 1
    s_cbranch_scc0 LW_73
LW_74:
    ds_read_b32 v28, v30 offset:44
    s_waitcnt lgkmcnt(0)
    v_readfirstlane_b32 s9, v28
    buffer_load_dword v52, v241, s[44:47], s60 offen sc1
    s_setprio 0
    s_cmp_eq_u32 s57, 0
    s_cbranch_scc0 L_mh1
    ds_write_b128 v38, v[164:167] offset:0
    ds_write_b128 v38, v[168:171] offset:1024
    s_mov_b64 exec, 1
    ds_add_u32 v30, v31 offset:0
    s_mov_b64 exec, -1
    ds_read_b32 v24, v30 offset:0
    s_waitcnt lgkmcnt(0)
    v_readfirstlane_b32 s10, v24
    s_nop 0
    s_cmp_ge_u32 s10, 4
    s_cbranch_scc0 LW_75
LW_76:
    ds_read_b128 v[96:99], v38 offset:2048
    ds_read_b128 v[100:103], v38 offset:3072
    s_mov_b64 exec, 1
    ds_add_u32 v30, v31 offset:0
    s_mov_b64 exec, -1
    s_waitcnt lgkmcnt(1)
    v_add_f32 v160, v160, v96
    v_add_f32 v164, v164, v100
    ds_bpermute_b32 v167, v252, v160
    v_readfirstlane_b32 s11, v164
    v_add_f32 v161, v161, v97
    v_add_f32 v162, v162, v98
    v_add_f32 v163, v163, v99
    v_add_f32 v165, v165, v101
    v_add_f32 v166, v166, v102
    s_mov_b32 s92, s11
    s_waitcnt vmcnt(0)
    v_cmp_ne_u32 vcc, s9, v52
    s_nop 0
    s_cbranch_vccnz LP_77
LP_79:
    buffer_load_dwordx4 v[56:59], v34, s[44:47], s61 offen sc1
    buffer_load_dwordx4 v[60:63], v34, s[44:47], s62 offen sc1
    v_cvt_pk_bf16_f32 v116, v166, v165
    v_cvt_pk_bf16_f32 v117, v164, v164
    ds_write_b64 v40, v[116:117] offset:3592
    ds_write2_b32 v42, v116, v117 offset0:0 offset1:1
    v_cvt_pk_bf16_f32 v118, v166, v166
    v_cvt_pk_bf16_f32 v119, v165, v164
    ds_write_b64 v40, v[118:119] offset:16072
    ds_write2_b32 v43, v118, v119 offset0:0 offset1:1
    s_waitcnt lgkmcnt(4)
    v_writelane_b32 v167, s92, 63
    v_cvt_pk_bf16_f32 v112, v163, v162
    v_cvt_pk_bf16_f32 v113, v161, v160
    ds_write_b64 v40, v[112:113] offset:4104
    ds_write2_b32 v42, v112, v113 offset0:128 offset1:129
    v_cvt_pk_bf16_f32 v114, v167, v163
    v_cvt_pk_bf16_f32 v115, v162, v161
    ds_write_b64 v40, v[114:115] offset:16584
    ds_write2_b32 v43, v114, v115 offset0:128 offset1:129
    v_cvt_pk_bf16_f32 v120, v160, v27
    s_mov_b64 exec, 1
    ds_write_b32 v40, v120 offset:8276
    ds_write_b32 v40, v120 offset:16592
    s_mov_b64 exec, -1
    s_branch L_mhj
L_mh1:
    ds_write_b128 v38, v[160:163] offset:2048
    ds_write_b128 v38, v[164:167] offset:3072
    s_mov_b64 exec, 1
    ds_add_u32 v30, v31 offset:0
    s_mov_b64 exec, -1
    ds_write_b128 v250, v[48:51] offset:128
    ds_write_b128 v251, v[48:51] offset:2048
    ds_read_b32 v24, v30 offset:0
    s_waitcnt lgkmcnt(0)
    v_readfirstlane_b32 s10, v24
    s_nop 0
    s_cmp_ge_u32 s10, 4
    s_cbranch_scc0 LW_80
LW_81:
    ds_read_b128 v[96:99], v38 offset:0
    ds_read_b128 v[100:103], v38 offset:1024
    s_mov_b64 exec, 1
    ds_add_u32 v30, v31 offset:0
    s_mov_b64 exec, -1
    s_waitcnt lgkmcnt(1)
    v_add_f32 v167, v167, v99
    v_add_f32 v168, v168, v100
    v_add_f32 v169, v169, v101
    v_add_f32 v170, v170, v102
    v_add_f32 v171, v171, v103
    s_waitcnt vmcnt(0)
    v_cmp_ne_u32 vcc, s9, v52
    s_nop 0
    s_cbranch_vccnz LP_82
LP_84:
    buffer_load_dwordx4 v[56:59], v34, s[44:47], s61 offen sc1
    buffer_load_dwordx4 v[60:63], v34, s[44:47], s62 offen sc1
    v_cvt_pk_bf16_f32 v112, v171, v167
    ds_write_b16 v249, v112 offset:134
    ds_write_b16_d16_hi v249, v112 offset:390
    ds_write_b16 v249, v112 offset:4300
    ds_write_b16_d16_hi v249, v112 offset:4556
    ds_write_b16 v249, v112 offset:8458
    ds_write_b16_d16_hi v249, v112 offset:8714
    ds_write_b16 v249, v112 offset:12616
    ds_write_b16_d16_hi v249, v112 offset:12872
    v_cvt_pk_bf16_f32 v128, v170, v170
    v_cvt_pk_bf16_f32 v129, v169, v169
    v_cvt_pk_bf16_f32 v130, v169, v168
    v_cvt_pk_bf16_f32 v131, v168, v168
    ds_write_b128 v41, v[128:131] offset:3072
    v_cvt_pk_bf16_f32 v132, v170, v170
    v_cvt_pk_bf16_f32 v133, v170, v170
    v_cvt_pk_bf16_f32 v134, v170, v169
    v_cvt_pk_bf16_f32 v135, v169, v169
    ds_write_b128 v41, v[132:135] offset:7232
    v_cvt_pk_bf16_f32 v136, v170, v170
    v_cvt_pk_bf16_f32 v137, v170, v170
    v_cvt_pk_bf16_f32 v138, v169, v169
    v_cvt_pk_bf16_f32 v139, v169, v168
    ds_write_b128 v41, v[136:139] offset:11392
    v_cvt_pk_bf16_f32 v140, v170, v170
    v_cvt_pk_bf16_f32 v141, v170, v169
    v_cvt_pk_bf16_f32 v142, v169, v169
    v_cvt_pk_bf16_f32 v143, v168, v168
    ds_write_b128 v41, v[140:143] offset:15552
    v_cvt_pk_bf16_f32 v114, v27, v170
    v_mov_b32 v115, v132
    s_mov_b64 exec, 1
    ds_write_b32 v40, v131 offset:7248
    ds_write_b32 v40, v131 offset:11408
    s_mov_b32 exec_lo, 0
    s_mov_b32 exec_hi, 0x80000000
    ds_write_b32 v41, v114 offset:3060
    ds_write_b64 v41, v[132:133] offset:3064
    ds_write_b32 v41, v132 offset:7228
    ds_write_b64 v41, v[114:115] offset:11384
    ds_write_b64 v41, v[132:133] offset:15544
    s_mov_b64 exec, -1
L_mhj:
    ds_read_b32 v24, v30 offset:0
    s_waitcnt lgkmcnt(0)
    v_readfirstlane_b32 s10, v24
    s_nop 0
    s_cmp_ge_u32 s10, 8
    s_cbranch_scc0 LW_85
LW_86:
    s_waitcnt vmcnt(1)
    ds_write_b128 v47, v[56:59] offset:480
    s_waitcnt vmcnt(0)
    ds_write_b128 v47, v[60:63] offset:992
    s_mov_b64 exec, 1
    ds_add_u32 v30, v31 offset:0
    s_mov_b64 exec, -1
    ds_read_b32 v24, v30 offset:0
    s_waitcnt lgkmcnt(0)
    v_readfirstlane_b32 s10, v24
    s_nop 0
    s_cmp_ge_u32 s10, 12
    s_cbranch_scc0 LW_87
LW_88:
    ds_read_b64 v[64:65], v232 offset:3776
    ds_read_b64 v[66:67], v232 offset:3784
    ds_read_b128 v[96:99], v233 offset:192
    ds_read_b64 v[68:69], v232 offset:3264
    ds_read_b64 v[70:71], v232 offset:3272
    ds_read_b128 v[100:103], v233 offset:704
    ds_read_b64 v[72:73], v232 offset:2752
    ds_read_b64 v[74:75], v232 offset:2760
    ds_read_b128 v[104:107], v233 offset:1216
    ds_read_b64 v[76:77], v232 offset:2240
    ds_read_b64 v[78:79], v232 offset:2248
    ds_read_b128 v[108:111], v233 offset:1728
    ds_read_b128 v[112:115], v233 offset:2240
    ds_read_b128 v[116:119], v233 offset:2752
    ds_read_b128 v[120:123], v233 offset:3264
    ds_read_b128 v[124:127], v233 offset:3776
    ds_read_b64 v[80:81], v248
    ds_read_b64 v[82:83], v248 offset:8
    ds_read_b128 v[144:147], v243 offset:0
    ds_read_b128 v[148:151], v243 offset:512
    ds_read_b128 v[152:155], v243 offset:1024
    ds_read_b128 v[156:159], v243 offset:1536
    ds_read_b128 v[224:227], v237 offset:480
    ds_read_b128 v[228:231], v237 offset:1504
    s_setprio 0
    s_waitcnt lgkmcnt(0)
    ds_read_b32 v24, v238 offset:0
    s_waitcnt lgkmcnt(0)
    v_readfirstlane_b32 s10, v24
    s_nop 0
    s_cmp_ge_u32 s10, 1
    s_cbranch_scc0 LW_89
LW_90:
    s_setprio 3
    s_waitcnt lgkmcnt(0)
    v_mfma_f32_16x16x32_bf16 v[4:7], v[144:147], v[244:247], 0
    ds_read_b64 v[128:129], v232 offset:3712
    v_mfma_f32_16x16x32_bf16 v[8:11], v[148:151], v[244:247], 0
    ds_read_b64 v[130:131], v232 offset:3720
    v_mfma_f32_16x16x32_bf16 v[12:15], v[152:155], v[244:247], 0
    ds_read_b128 v[160:163], v233 offset:128
    v_mfma_f32_16x16x32_bf16 v[16:19], v[156:159], v[244:247], 0
    ds_read_b64 v[132:133], v232 offset:3200
    v_mfma_f32_16x16x32_bf16 v[192:195], v[64:67], v[96:99], 0
    ds_read_b64 v[134:135], v232 offset:3208
    v_mfma_f32_16x16x32_bf16 v[196:199], v[64:67], v[100:103], 0
    ds_read_b128 v[164:167], v233 offset:640
    v_mfma_f32_16x16x32_bf16 v[200:203], v[64:67], v[104:107], 0
    ds_read_b64 v[136:137], v232 offset:2688
    v_mfma_f32_16x16x32_bf16 v[204:207], v[64:67], v[108:111], 0
    ds_read_b64 v[138:139], v232 offset:2696
    v_mfma_f32_16x16x32_bf16 v[208:211], v[64:67], v[112:115], 0
    ds_read_b128 v[168:171], v233 offset:1152
    v_mfma_f32_16x16x32_bf16 v[212:215], v[64:67], v[116:119], 0
    ds_read_b64 v[140:141], v232 offset:2176
    v_mfma_f32_16x16x32_bf16 v[216:219], v[64:67], v[120:123], 0
    ds_read_b64 v[142:143], v232 offset:2184
    v_mfma_f32_16x16x32_bf16 v[220:223], v[64:67], v[124:127], 0
    ds_read_b128 v[172:175], v233 offset:1664
    v_mfma_f32_16x16x32_bf16 v[196:199], v[68:71], v[96:99], v[196:199]
    ds_read_b128 v[176:179], v233 offset:2176
    v_mfma_f32_16x16x32_bf16 v[200:203], v[68:71], v[100:103], v[200:203]
    ds_read_b128 v[180:183], v233 offset:2688
    v_mfma_f32_16x16x32_bf16 v[204:207], v[68:71], v[104:107], v[204:207]
    ds_read_b128 v[184:187], v233 offset:3200
    v_mfma_f32_16x16x32_bf16 v[208:211], v[68:71], v[108:111], v[208:211]
    ds_read_b128 v[188:191], v233 offset:3712
    v_mfma_f32_16x16x32_bf16 v[212:215], v[68:71], v[112:115], v[212:215]
    v_cvt_pk_bf16_f32 v84, v4, v5
    v_mfma_f32_16x16x32_bf16 v[216:219], v[68:71], v[116:119], v[216:219]
    v_cvt_pk_bf16_f32 v85, v6, v7
    v_mfma_f32_16x16x32_bf16 v[220:223], v[68:71], v[120:123], v[220:223]
    v_cvt_pk_bf16_f32 v86, v8, v9
    v_mfma_f32_16x16x32_bf16 v[200:203], v[72:75], v[96:99], v[200:203]
    v_cvt_pk_bf16_f32 v87, v10, v11
    v_mfma_f32_16x16x32_bf16 v[204:207], v[72:75], v[100:103], v[204:207]
    v_cvt_pk_bf16_f32 v88, v12, v13
    v_mfma_f32_16x16x32_bf16 v[208:211], v[72:75], v[104:107], v[208:211]
    v_cvt_pk_bf16_f32 v89, v14, v15
    v_mfma_f32_16x16x32_bf16 v[212:215], v[72:75], v[108:111], v[212:215]
    v_cvt_pk_bf16_f32 v90, v16, v17
    v_mfma_f32_16x16x32_bf16 v[216:219], v[72:75], v[112:115], v[216:219]
    v_cvt_pk_bf16_f32 v91, v18, v19
    v_mfma_f32_16x16x32_bf16 v[220:223], v[72:75], v[116:119], v[220:223]
    v_mfma_f32_16x16x32_bf16 v[204:207], v[76:79], v[96:99], v[204:207]
    v_mfma_f32_16x16x32_bf16 v[208:211], v[76:79], v[100:103], v[208:211]
    v_mfma_f32_16x16x32_bf16 v[212:215], v[76:79], v[104:107], v[212:215]
    v_mfma_f32_16x16x32_bf16 v[216:219], v[76:79], v[108:111], v[216:219]
    v_mfma_f32_16x16x32_bf16 v[220:223], v[76:79], v[112:115], v[220:223]
    v_mfma_f32_16x16x32_bf16 v[208:211], v[80:83], v[96:99], v[208:211]
    v_mfma_f32_16x16x32_bf16 v[212:215], v[80:83], v[100:103], v[212:215]
    v_mfma_f32_16x16x32_bf16 v[216:219], v[80:83], v[104:107], v[216:219]
    v_mfma_f32_16x16x32_bf16 v[220:223], v[80:83], v[108:111], v[220:223]
    s_waitcnt lgkmcnt(0)
    v_mfma_f32_16x16x32_bf16 v[192:195], v[128:131], v[160:163], v[192:195]
    ds_read_b64 v[64:65], v232 offset:3648
    v_mfma_f32_16x16x32_bf16 v[196:199], v[128:131], v[164:167], v[196:199]
    ds_read_b64 v[66:67], v232 offset:3656
    v_mfma_f32_16x16x32_bf16 v[200:203], v[128:131], v[168:171], v[200:203]
    ds_read_b128 v[96:99], v233 offset:64
    v_mfma_f32_16x16x32_bf16 v[204:207], v[128:131], v[172:175], v[204:207]
    ds_read_b64 v[68:69], v232 offset:3136
    v_mfma_f32_16x16x32_bf16 v[208:211], v[128:131], v[176:179], v[208:211]
    ds_read_b64 v[70:71], v232 offset:3144
    v_mfma_f32_16x16x32_bf16 v[212:215], v[128:131], v[180:183], v[212:215]
    ds_read_b128 v[100:103], v233 offset:576
    v_mfma_f32_16x16x32_bf16 v[216:219], v[128:131], v[184:187], v[216:219]
    ds_read_b64 v[72:73], v232 offset:2624
    v_mfma_f32_16x16x32_bf16 v[220:223], v[128:131], v[188:191], v[220:223]
    ds_read_b64 v[74:75], v232 offset:2632
    v_mfma_f32_16x16x32_bf16 v[196:199], v[132:135], v[160:163], v[196:199]
    ds_read_b128 v[104:107], v233 offset:1088
    v_mfma_f32_16x16x32_bf16 v[200:203], v[132:135], v[164:167], v[200:203]
    ds_read_b64 v[76:77], v232 offset:2112
    v_mfma_f32_16x16x32_bf16 v[204:207], v[132:135], v[168:171], v[204:207]
    ds_read_b64 v[78:79], v232 offset:2120
    v_mfma_f32_16x16x32_bf16 v[208:211], v[132:135], v[172:175], v[208:211]
    ds_read_b128 v[108:111], v233 offset:1600
    v_mfma_f32_16x16x32_bf16 v[212:215], v[132:135], v[176:179], v[212:215]
    ds_read_b128 v[112:115], v233 offset:2112
    v_mfma_f32_16x16x32_bf16 v[216:219], v[132:135], v[180:183], v[216:219]
    ds_read_b128 v[116:119], v233 offset:2624
    v_mfma_f32_16x16x32_bf16 v[220:223], v[132:135], v[184:187], v[220:223]
    ds_read_b128 v[120:123], v233 offset:3136
    v_mfma_f32_16x16x32_bf16 v[200:203], v[136:139], v[160:163], v[200:203]
    ds_read_b128 v[124:127], v233 offset:3648
    v_mfma_f32_16x16x32_bf16 v[204:207], v[136:139], v[164:167], v[204:207]
    ds_read_b64 v[144:145], v242 offset:96
    v_mfma_f32_16x16x32_bf16 v[208:211], v[136:139], v[168:171], v[208:211]
    ds_read_b64 v[146:147], v242 offset:128
    v_mfma_f32_16x16x32_bf16 v[212:215], v[136:139], v[172:175], v[212:215]
    ds_read_b64 v[148:149], v242 offset:64
    v_mfma_f32_16x16x32_bf16 v[216:219], v[136:139], v[176:179], v[216:219]
    ds_read_b64 v[150:151], v242 offset:96
    v_mfma_f32_16x16x32_bf16 v[220:223], v[136:139], v[180:183], v[220:223]
    ds_read_b64 v[152:153], v242 offset:32
    v_mfma_f32_16x16x32_bf16 v[204:207], v[140:143], v[160:163], v[204:207]
    ds_read_b64 v[154:155], v242 offset:64
    v_mfma_f32_16x16x32_bf16 v[208:211], v[140:143], v[164:167], v[208:211]
    ds_read_b64 v[156:157], v242 offset:0
    v_mfma_f32_16x16x32_bf16 v[212:215], v[140:143], v[168:171], v[212:215]
    ds_read_b64 v[158:159], v242 offset:32
    v_mfma_f32_16x16x32_bf16 v[216:219], v[140:143], v[172:175], v[216:219]
    v_mfma_f32_16x16x32_bf16 v[220:223], v[140:143], v[176:179], v[220:223]
    s_waitcnt lgkmcnt(0)
    v_mfma_f32_16x16x32_bf16 v[208:211], v[84:87], v[144:147], v[208:211]
    ds_read_b64 v[128:129], v232 offset:3584
    v_mfma_f32_16x16x32_bf16 v[212:215], v[84:87], v[148:151], v[212:215]
    ds_read_b64 v[130:131], v232 offset:3592
    v_mfma_f32_16x16x32_bf16 v[216:219], v[84:87], v[152:155], v[216:219]
    ds_read_b128 v[160:163], v233 offset:0
    v_mfma_f32_16x16x32_bf16 v[220:223], v[84:87], v[156:159], v[220:223]
    ds_read_b64 v[132:133], v232 offset:3072
    v_mfma_f32_16x16x32_bf16 v[216:219], v[88:91], v[144:147], v[216:219]
    ds_read_b64 v[134:135], v232 offset:3080
    v_mfma_f32_16x16x32_bf16 v[220:223], v[88:91], v[148:151], v[220:223]
    ds_read_b128 v[164:167], v233 offset:512
    v_mfma_f32_16x16x32_bf16 v[192:195], v[64:67], v[96:99], v[192:195]
    ds_read_b64 v[136:137], v232 offset:2560
    v_mfma_f32_16x16x32_bf16 v[196:199], v[64:67], v[100:103], v[196:199]
    ds_read_b64 v[138:139], v232 offset:2568
    v_mfma_f32_16x16x32_bf16 v[200:203], v[64:67], v[104:107], v[200:203]
    ds_read_b128 v[168:171], v233 offset:1024
    v_mfma_f32_16x16x32_bf16 v[204:207], v[64:67], v[108:111], v[204:207]
    ds_read_b64 v[140:141], v232 offset:2048
    v_mfma_f32_16x16x32_bf16 v[208:211], v[64:67], v[112:115], v[208:211]
    ds_read_b64 v[142:143], v232 offset:2056
    v_mfma_f32_16x16x32_bf16 v[212:215], v[64:67], v[116:119], v[212:215]
    ds_read_b128 v[172:175], v233 offset:1536
    v_mfma_f32_16x16x32_bf16 v[216:219], v[64:67], v[120:123], v[216:219]
    ds_read_b128 v[176:179], v233 offset:2048
    v_mfma_f32_16x16x32_bf16 v[220:223], v[64:67], v[124:127], v[220:223]
    ds_read_b128 v[180:183], v233 offset:2560
    v_mfma_f32_16x16x32_bf16 v[196:199], v[68:71], v[96:99], v[196:199]
    ds_read_b128 v[184:187], v233 offset:3072
    v_mfma_f32_16x16x32_bf16 v[200:203], v[68:71], v[100:103], v[200:203]
    ds_read_b128 v[188:191], v233 offset:3584
    v_mfma_f32_16x16x32_bf16 v[204:207], v[68:71], v[104:107], v[204:207]
    v_mfma_f32_16x16x32_bf16 v[208:211], v[68:71], v[108:111], v[208:211]
    v_mfma_f32_16x16x32_bf16 v[212:215], v[68:71], v[112:115], v[212:215]
    v_mfma_f32_16x16x32_bf16 v[216:219], v[68:71], v[116:119], v[216:219]
    v_mfma_f32_16x16x32_bf16 v[220:223], v[68:71], v[120:123], v[220:223]
    v_mfma_f32_16x16x32_bf16 v[200:203], v[72:75], v[96:99], v[200:203]
    v_mfma_f32_16x16x32_bf16 v[204:207], v[72:75], v[100:103], v[204:207]
    v_mfma_f32_16x16x32_bf16 v[208:211], v[72:75], v[104:107], v[208:211]
    v_mfma_f32_16x16x32_bf16 v[212:215], v[72:75], v[108:111], v[212:215]
    v_mfma_f32_16x16x32_bf16 v[216:219], v[72:75], v[112:115], v[216:219]
    v_mfma_f32_16x16x32_bf16 v[220:223], v[72:75], v[116:119], v[220:223]
    v_mfma_f32_16x16x32_bf16 v[204:207], v[76:79], v[96:99], v[204:207]
    v_mfma_f32_16x16x32_bf16 v[208:211], v[76:79], v[100:103], v[208:211]
    v_mfma_f32_16x16x32_bf16 v[212:215], v[76:79], v[104:107], v[212:215]
    v_mfma_f32_16x16x32_bf16 v[216:219], v[76:79], v[108:111], v[216:219]
    v_mfma_f32_16x16x32_bf16 v[220:223], v[76:79], v[112:115], v[220:223]
    s_waitcnt lgkmcnt(0)
    s_mov_b64 exec, 1
    ds_add_u32 v30, v31 offset:0
    s_mov_b64 exec, -1
    v_mfma_f32_16x16x32_bf16 v[192:195], v[128:131], v[160:163], v[192:195]
    v_lshlrev_b32 v48, 16, v224
    v_mfma_f32_16x16x32_bf16 v[196:199], v[128:131], v[164:167], v[196:199]
    v_lshlrev_b32 v50, 16, v225
    v_mfma_f32_16x16x32_bf16 v[200:203], v[128:131], v[168:171], v[200:203]
    v_lshlrev_b32 v52, 16, v226
    v_mfma_f32_16x16x32_bf16 v[204:207], v[128:131], v[172:175], v[204:207]
    v_lshlrev_b32 v54, 16, v227
    v_mfma_f32_16x16x32_bf16 v[208:211], v[128:131], v[176:179], v[208:211]
    v_lshlrev_b32 v56, 16, v228
    v_mfma_f32_16x16x32_bf16 v[212:215], v[128:131], v[180:183], v[212:215]
    v_lshlrev_b32 v58, 16, v229
    v_mfma_f32_16x16x32_bf16 v[216:219], v[128:131], v[184:187], v[216:219]
    v_lshlrev_b32 v60, 16, v230
    v_mfma_f32_16x16x32_bf16 v[220:223], v[128:131], v[188:191], v[220:223]
    v_lshlrev_b32 v62, 16, v231
    v_mfma_f32_16x16x32_bf16 v[196:199], v[132:135], v[160:163], v[196:199]
    v_and_b32 v49, s13, v224
    v_mfma_f32_16x16x32_bf16 v[200:203], v[132:135], v[164:167], v[200:203]
    v_and_b32 v51, s13, v225
    v_mfma_f32_16x16x32_bf16 v[204:207], v[132:135], v[168:171], v[204:207]
    v_and_b32 v53, s13, v226
    v_mfma_f32_16x16x32_bf16 v[208:211], v[132:135], v[172:175], v[208:211]
    v_and_b32 v55, s13, v227
    v_mfma_f32_16x16x32_bf16 v[212:215], v[132:135], v[176:179], v[212:215]
    v_and_b32 v57, s13, v228
    v_mfma_f32_16x16x32_bf16 v[216:219], v[132:135], v[180:183], v[216:219]
    v_and_b32 v59, s13, v229
    v_mfma_f32_16x16x32_bf16 v[220:223], v[132:135], v[184:187], v[220:223]
    v_and_b32 v61, s13, v230
    v_mfma_f32_16x16x32_bf16 v[200:203], v[136:139], v[160:163], v[200:203]
    v_and_b32 v63, s13, v231
    v_mfma_f32_16x16x32_bf16 v[204:207], v[136:139], v[164:167], v[204:207]
    v_mfma_f32_16x16x32_bf16 v[208:211], v[136:139], v[168:171], v[208:211]
    v_mfma_f32_16x16x32_bf16 v[212:215], v[136:139], v[172:175], v[212:215]
    v_mfma_f32_16x16x32_bf16 v[216:219], v[136:139], v[176:179], v[216:219]
    v_mfma_f32_16x16x32_bf16 v[220:223], v[136:139], v[180:183], v[220:223]
    v_mfma_f32_16x16x32_bf16 v[204:207], v[140:143], v[160:163], v[204:207]
    v_mfma_f32_16x16x32_bf16 v[208:211], v[140:143], v[164:167], v[208:211]
    v_mfma_f32_16x16x32_bf16 v[212:215], v[140:143], v[168:171], v[212:215]
    v_mfma_f32_16x16x32_bf16 v[216:219], v[140:143], v[172:175], v[216:219]
    v_mfma_f32_16x16x32_bf16 v[220:223], v[140:143], v[176:179], v[220:223]
    s_setprio 3
    ds_read_b32 v24, v30 offset:0
    s_waitcnt lgkmcnt(0)
    v_readfirstlane_b32 s10, v24
    s_nop 0
    s_cmp_ge_u32 s10, 16
    s_cbranch_scc0 LW_91
LW_92:
    ds_write_b128 v234, v[192:195] offset:0
    ds_write_b128 v234, v[196:199] offset:1024
    ds_write_b128 v234, v[200:203] offset:2048
    ds_write_b128 v234, v[204:207] offset:3072
    ds_write_b128 v234, v[208:211] offset:4096
    ds_write_b128 v234, v[212:215] offset:5120
    ds_write_b128 v234, v[216:219] offset:6144
    ds_write_b128 v234, v[220:223] offset:7168
    s_mov_b64 exec, 1
    ds_add_u32 v30, v31 offset:0
    s_mov_b64 exec, -1
    ds_read_b32 v24, v30 offset:0
    s_waitcnt lgkmcnt(0)
    v_readfirstlane_b32 s10, v24
    s_nop 0
    s_cmp_ge_u32 s10, 20
    s_cbranch_scc0 LW_93
LW_94:
    ds_read_b128 v[96:99], v235 offset:0
    ds_read_b128 v[100:103], v236 offset:0
    ds_read_b128 v[104:107], v235 offset:8192
    ds_read_b128 v[108:111], v236 offset:8192
    ds_read_b128 v[112:115], v235 offset:2048
    ds_read_b128 v[116:119], v236 offset:2048
    ds_read_b128 v[120:123], v235 offset:10240
    ds_read_b128 v[124:127], v236 offset:10240
    s_waitcnt lgkmcnt(4)
    v_add_f32 v96, v96, v104
    v_fmac_f32 v96, s34, v48
    v_add_f32 v97, v97, v105
    v_fmac_f32 v97, s34, v49
    v_cvt_pk_bf16_f32 v64, v96, v97
    v_add_f32 v98, v98, v106
    v_fmac_f32 v98, s34, v50
    v_add_f32 v99, v99, v107
    v_fmac_f32 v99, s34, v51
    v_cvt_pk_bf16_f32 v65, v98, v99
    v_add_f32 v100, v100, v108
    v_fmac_f32 v100, s34, v52
    v_add_f32 v101, v101, v109
    v_fmac_f32 v101, s34, v53
    v_cvt_pk_bf16_f32 v66, v100, v101
    v_add_f32 v102, v102, v110
    v_fmac_f32 v102, s34, v54
    v_add_f32 v103, v103, v111
    v_fmac_f32 v103, s34, v55
    v_cvt_pk_bf16_f32 v67, v102, v103
    buffer_store_dwordx4 v[64:67], v26, s[44:47], s63 offen offset:0 sc1
    v_add3_u32 v72, v64, v65, s9
    v_add3_u32 v72, v66, v67, v72
    buffer_store_dword v72, v35, s[44:47], s50 offen offset:0 sc1
    s_waitcnt lgkmcnt(0)
    v_add_f32 v112, v112, v120
    v_fmac_f32 v112, s34, v56
    v_add_f32 v113, v113, v121
    v_fmac_f32 v113, s34, v57
    v_cvt_pk_bf16_f32 v68, v112, v113
    v_add_f32 v114, v114, v122
    v_fmac_f32 v114, s34, v58
    v_add_f32 v115, v115, v123
    v_fmac_f32 v115, s34, v59
    v_cvt_pk_bf16_f32 v69, v114, v115
    v_add_f32 v116, v116, v124
    v_fmac_f32 v116, s34, v60
    v_add_f32 v117, v117, v125
    v_fmac_f32 v117, s34, v61
    v_cvt_pk_bf16_f32 v70, v116, v117
    v_add_f32 v118, v118, v126
    v_fmac_f32 v118, s34, v62
    v_add_f32 v119, v119, v127
    v_fmac_f32 v119, s34, v63
    v_cvt_pk_bf16_f32 v71, v118, v119
    buffer_store_dwordx4 v[68:71], v26, s[44:47], s63 offen offset:1024 sc1
    v_add3_u32 v73, v68, v69, s9
    v_add3_u32 v73, v70, v71, v73
    buffer_store_dword v73, v35, s[44:47], s50 offen offset:256 sc1
    s_or_b32 s10, s2, s3
    s_cmp_eq_u32 s10, 0
    s_cbranch_scc0 L_Sdone
    s_mov_b32 s11, 0x8000
L_nu:
    s_mov_b32 s60, 262144
    buffer_load_dword v128, v241, s[44:47], s60 offen sc1
    s_add_u32 s60, s60, 512
    buffer_load_dword v129, v241, s[44:47], s60 offen sc1
    s_add_u32 s60, s60, 512
    buffer_load_dword v130, v241, s[44:47], s60 offen sc1
    s_add_u32 s60, s60, 512
    buffer_load_dword v131, v241, s[44:47], s60 offen sc1
    s_add_u32 s60, s60, 512
    s_waitcnt vmcnt(0)
    v_xor_b32 v128, s9, v128
    v_xor_b32 v129, s9, v129
    v_xor_b32 v130, s9, v130
    v_xor_b32 v131, s9, v131
    v_or_b32 v128, v128, v129
    v_or3_b32 v128, v128, v130, v131
    v_cmp_ne_u32 vcc, 0, v128
    s_sub_u32 s11, s11, 1
    s_cbranch_scc1 L_nud
    s_cbranch_vccnz L_nu
L_nud:
    s_mov_b64 exec, 1
    buffer_store_dword v28, v27, s[44:47], 0 offen sc1
    s_mov_b64 exec, -1
L_Sdone:
    s_endpgm
LW_1:
    ds_read_b32 v11, v43 offset:8
    s_waitcnt lgkmcnt(0)
    v_readfirstlane_b32 s10, v11
    s_nop 0
    s_cmp_ge_u32 s10, 4
    s_cbranch_scc0 LW_1
    s_branch LW_2
LC_3:
    ds_read_b128 v[156:159], v30 offset:0
    s_waitcnt lgkmcnt(0)
    v_min3_u32 v156, v156, v157, v158
    v_min_u32 v156, v156, v159
    s_nop 0
    v_readfirstlane_b32 s10, v156
    s_nop 0
    s_cmp_lg_u32 s10, 0
    s_cbranch_scc0 LC_3
    s_branch LC_4
LC_5:
    ds_read_b128 v[156:159], v30 offset:16
    s_waitcnt lgkmcnt(0)
    v_min3_u32 v156, v156, v157, v158
    v_min_u32 v156, v156, v159
    s_nop 0
    v_readfirstlane_b32 s10, v156
    s_nop 0
    s_cmp_lg_u32 s10, 0
    s_cbranch_scc0 LC_5
    s_branch LC_6
LC_7:
    ds_read_b128 v[156:159], v30 offset:32
    s_waitcnt lgkmcnt(0)
    v_min3_u32 v156, v156, v157, v158
    v_min_u32 v156, v156, v159
    s_nop 0
    v_readfirstlane_b32 s10, v156
    s_nop 0
    s_cmp_lg_u32 s10, 0
    s_cbranch_scc0 LC_7
    s_branch LC_8
LC_9:
    ds_read_b128 v[156:159], v30 offset:48
    s_waitcnt lgkmcnt(0)
    v_min3_u32 v156, v156, v157, v158
    v_min_u32 v156, v156, v159
    s_nop 0
    v_readfirstlane_b32 s10, v156
    s_nop 0
    s_cmp_lg_u32 s10, 0
    s_cbranch_scc0 LC_9
    s_branch LC_10
LC_11:
    ds_read_b128 v[156:159], v30 offset:64
    s_waitcnt lgkmcnt(0)
    v_min3_u32 v156, v156, v157, v158
    v_min_u32 v156, v156, v159
    s_nop 0
    v_readfirstlane_b32 s10, v156
    s_nop 0
    s_cmp_lg_u32 s10, 0
    s_cbranch_scc0 LC_11
    s_branch LC_12
LC_13:
    ds_read_b128 v[156:159], v30 offset:80
    s_waitcnt lgkmcnt(0)
    v_min3_u32 v156, v156, v157, v158
    v_min_u32 v156, v156, v159
    s_nop 0
    v_readfirstlane_b32 s10, v156
    s_nop 0
    s_cmp_lg_u32 s10, 0
    s_cbranch_scc0 LC_13
    s_branch LC_14
LC_15:
    ds_read_b128 v[156:159], v30 offset:96
    s_waitcnt lgkmcnt(0)
    v_min3_u32 v156, v156, v157, v158
    v_min_u32 v156, v156, v159
    s_nop 0
    v_readfirstlane_b32 s10, v156
    s_nop 0
    s_cmp_lg_u32 s10, 0
    s_cbranch_scc0 LC_15
    s_branch LC_16
LC_17:
    ds_read_b128 v[156:159], v30 offset:112
    s_waitcnt lgkmcnt(0)
    v_min3_u32 v156, v156, v157, v158
    v_min_u32 v156, v156, v159
    s_nop 0
    v_readfirstlane_b32 s10, v156
    s_nop 0
    s_cmp_lg_u32 s10, 0
    s_cbranch_scc0 LC_17
    s_branch LC_18
LS_19:
    s_mov_b32 s11, 0x8000
LS_20:
    s_sleep 2
    buffer_load_dwordx2 v[152:153], v40, s[44:47], s27 offen sc1
    s_waitcnt vmcnt(0)
    v_cmp_ne_u32 vcc, s9, v153
    s_nop 0
    s_cbranch_vccz LS_21
    s_sub_u32 s11, s11, 1
    s_cbranch_scc0 LS_20
    s_branch LS_21
LW_22:
    ds_read_b32 v11, v43 offset:0
    s_waitcnt lgkmcnt(0)
    v_readfirstlane_b32 s10, v11
    s_nop 0
    s_cmp_ge_u32 s10, 4
    s_cbranch_scc0 LW_22
    s_branch LW_23
L_mir1:
L_mir2:
    s_branch L_skipu2
LH_24:
    s_mov_b32 s11, 0x2000
    s_mov_b32 s92, s41
    s_waitcnt vmcnt(0)
LH_25:
    s_sleep 4
    s_cmp_lt_u32 s11, 0x1ff4
    s_cselect_b32 s10, 163840, 0
    s_add_u32 s92, s92, s10
    s_cmp_ge_u32 s92, 163840
    s_cselect_b32 s92, 0, s92
    s_sub_u32 s93, s35, s41
    s_add_u32 s93, s93, s92
    buffer_load_dwordx4 v[48:51], v26, s[44:47], s93 offen offset:0 sc1
    buffer_load_dwordx4 v[52:55], v26, s[44:47], s93 offen offset:1024 sc1
    buffer_load_dwordx4 v[56:59], v26, s[44:47], s93 offen offset:2048 sc1
    buffer_load_dwordx4 v[60:63], v26, s[44:47], s93 offen offset:3072 sc1
    s_sub_u32 s10, s93, 0
    buffer_load_dwordx4 v[2:5], v28, s[44:47], s10 offen sc1
    s_waitcnt vmcnt(0)
    v_add3_u32 v10, v48, v49, s9
    v_add3_u32 v11, v56, v57, s9
    v_add3_u32 v10, v50, v51, v10
    v_add3_u32 v11, v58, v59, v11
    v_add3_u32 v10, v52, v53, v10
    v_add3_u32 v11, v60, v61, v11
    v_add3_u32 v10, v54, v55, v10
    v_add3_u32 v11, v62, v63, v11
    s_nop 1
    v_permlane16_swap_b32 v10, v11
    v_add_u32 v10, v10, v11
    v_cmp_ne_u32 vcc, v10, v2
    s_nop 0
    s_cbranch_vccz LH_27
    s_sub_u32 s11, s11, 1
    s_cbranch_scc0 LH_25
LH_27:
    s_mov_b32 s10, s35
    s_add_u32 s10, s10, 163840
    buffer_load_dwordx4 v[64:67], v26, s[44:47], s10 offen offset:0 sc1
    buffer_load_dwordx4 v[68:71], v26, s[44:47], s10 offen offset:1024 sc1
    buffer_load_dwordx4 v[72:75], v26, s[44:47], s10 offen offset:2048 sc1
    buffer_load_dwordx4 v[76:79], v26, s[44:47], s10 offen offset:3072 sc1
    s_add_u32 s10, s10, 163840
    buffer_load_dwordx4 v[80:83], v26, s[44:47], s10 offen offset:0 sc1
    buffer_load_dwordx4 v[84:87], v26, s[44:47], s10 offen offset:1024 sc1
    buffer_load_dwordx4 v[88:91], v26, s[44:47], s10 offen offset:2048 sc1
    buffer_load_dwordx4 v[92:95], v26, s[44:47], s10 offen offset:3072 sc1
    s_branch LH_26
LH_28:
    s_mov_b32 s11, 0x2000
    s_mov_b32 s92, s41
    s_waitcnt vmcnt(0)
LH_29:
    s_sleep 4
    s_cmp_lt_u32 s11, 0x1ff4
    s_cselect_b32 s10, 163840, 0
    s_add_u32 s92, s92, s10
    s_cmp_ge_u32 s92, 163840
    s_cselect_b32 s92, 0, s92
    s_sub_u32 s93, s35, s41
    s_add_u32 s93, s93, s92
    buffer_load_dwordx4 v[64:67], v26, s[44:47], s93 offen offset:0 sc1
    buffer_load_dwordx4 v[68:71], v26, s[44:47], s93 offen offset:1024 sc1
    buffer_load_dwordx4 v[72:75], v26, s[44:47], s93 offen offset:2048 sc1
    buffer_load_dwordx4 v[76:79], v26, s[44:47], s93 offen offset:3072 sc1
    s_sub_u32 s10, s93, 163840
    buffer_load_dwordx4 v[2:5], v28, s[44:47], s10 offen sc1
    s_waitcnt vmcnt(0)
    v_add3_u32 v10, v64, v65, s9
    v_add3_u32 v11, v72, v73, s9
    v_add3_u32 v10, v66, v67, v10
    v_add3_u32 v11, v74, v75, v11
    v_add3_u32 v10, v68, v69, v10
    v_add3_u32 v11, v76, v77, v11
    v_add3_u32 v10, v70, v71, v10
    v_add3_u32 v11, v78, v79, v11
    s_nop 1
    v_permlane16_swap_b32 v10, v11
    v_add_u32 v10, v10, v11
    v_cmp_ne_u32 vcc, v10, v3
    s_nop 0
    s_cbranch_vccz LH_31
    s_sub_u32 s11, s11, 1
    s_cbranch_scc0 LH_29
LH_31:
    s_mov_b32 s10, s35
    s_add_u32 s10, s10, 163840
    buffer_load_dwordx4 v[80:83], v26, s[44:47], s10 offen offset:0 sc1
    buffer_load_dwordx4 v[84:87], v26, s[44:47], s10 offen offset:1024 sc1
    buffer_load_dwordx4 v[88:91], v26, s[44:47], s10 offen offset:2048 sc1
    buffer_load_dwordx4 v[92:95], v26, s[44:47], s10 offen offset:3072 sc1
    s_add_u32 s10, s10, 163840
    buffer_load_dwordx4 v[96:99], v26, s[44:47], s10 offen offset:0 sc1
    buffer_load_dwordx4 v[100:103], v26, s[44:47], s10 offen offset:1024 sc1
    buffer_load_dwordx4 v[104:107], v26, s[44:47], s10 offen offset:2048 sc1
    buffer_load_dwordx4 v[108:111], v26, s[44:47], s10 offen offset:3072 sc1
    buffer_load_dwordx4 v[6:9], v28, s[44:47], s10 offen sc1
    s_branch LH_30
LH_32:
    s_mov_b32 s11, 0x2000
    s_mov_b32 s92, s41
    s_waitcnt vmcnt(0)
LH_33:
    s_sleep 4
    s_cmp_lt_u32 s11, 0x1ff4
    s_cselect_b32 s10, 163840, 0
    s_add_u32 s92, s92, s10
    s_cmp_ge_u32 s92, 163840
    s_cselect_b32 s92, 0, s92
    s_sub_u32 s93, s35, s41
    s_add_u32 s93, s93, s92
    buffer_load_dwordx4 v[80:83], v26, s[44:47], s93 offen offset:0 sc1
    buffer_load_dwordx4 v[84:87], v26, s[44:47], s93 offen offset:1024 sc1
    buffer_load_dwordx4 v[88:91], v26, s[44:47], s93 offen offset:2048 sc1
    buffer_load_dwordx4 v[92:95], v26, s[44:47], s93 offen offset:3072 sc1
    s_sub_u32 s10, s93, 327680
    buffer_load_dwordx4 v[2:5], v28, s[44:47], s10 offen sc1
    s_waitcnt vmcnt(0)
    v_add3_u32 v10, v80, v81, s9
    v_add3_u32 v11, v88, v89, s9
    v_add3_u32 v10, v82, v83, v10
    v_add3_u32 v11, v90, v91, v11
    v_add3_u32 v10, v84, v85, v10
    v_add3_u32 v11, v92, v93, v11
    v_add3_u32 v10, v86, v87, v10
    v_add3_u32 v11, v94, v95, v11
    s_nop 1
    v_permlane16_swap_b32 v10, v11
    v_add_u32 v10, v10, v11
    v_cmp_ne_u32 vcc, v10, v4
    s_nop 0
    s_cbranch_vccz LH_35
    s_sub_u32 s11, s11, 1
    s_cbranch_scc0 LH_33
LH_35:
    s_mov_b32 s10, s35
    s_add_u32 s10, s10, 163840
    buffer_load_dwordx4 v[96:99], v26, s[44:47], s10 offen offset:0 sc1
    buffer_load_dwordx4 v[100:103], v26, s[44:47], s10 offen offset:1024 sc1
    buffer_load_dwordx4 v[104:107], v26, s[44:47], s10 offen offset:2048 sc1
    buffer_load_dwordx4 v[108:111], v26, s[44:47], s10 offen offset:3072 sc1
    buffer_load_dwordx4 v[6:9], v28, s[44:47], s10 offen sc1
    s_add_u32 s10, s10, 163840
    buffer_load_dwordx4 v[48:51], v26, s[44:47], s10 offen offset:0 sc1
    buffer_load_dwordx4 v[52:55], v26, s[44:47], s10 offen offset:1024 sc1
    buffer_load_dwordx4 v[56:59], v26, s[44:47], s10 offen offset:2048 sc1
    buffer_load_dwordx4 v[60:63], v26, s[44:47], s10 offen offset:3072 sc1
    s_branch LH_34
LH_36:
    s_mov_b32 s11, 0x2000
    s_mov_b32 s92, s41
    s_waitcnt vmcnt(0)
LH_37:
    s_sleep 4
    s_cmp_lt_u32 s11, 0x1ff4
    s_cselect_b32 s10, 163840, 0
    s_add_u32 s92, s92, s10
    s_cmp_ge_u32 s92, 163840
    s_cselect_b32 s92, 0, s92
    s_sub_u32 s93, s35, s41
    s_add_u32 s93, s93, s92
    buffer_load_dwordx4 v[96:99], v26, s[44:47], s93 offen offset:0 sc1
    buffer_load_dwordx4 v[100:103], v26, s[44:47], s93 offen offset:1024 sc1
    buffer_load_dwordx4 v[104:107], v26, s[44:47], s93 offen offset:2048 sc1
    buffer_load_dwordx4 v[108:111], v26, s[44:47], s93 offen offset:3072 sc1
    s_sub_u32 s10, s93, 0
    buffer_load_dwordx4 v[6:9], v28, s[44:47], s10 offen sc1
    s_waitcnt vmcnt(0)
    v_add3_u32 v10, v96, v97, s9
    v_add3_u32 v11, v104, v105, s9
    v_add3_u32 v10, v98, v99, v10
    v_add3_u32 v11, v106, v107, v11
    v_add3_u32 v10, v100, v101, v10
    v_add3_u32 v11, v108, v109, v11
    v_add3_u32 v10, v102, v103, v10
    v_add3_u32 v11, v110, v111, v11
    s_nop 1
    v_permlane16_swap_b32 v10, v11
    v_add_u32 v10, v10, v11
    v_cmp_ne_u32 vcc, v10, v6
    s_nop 0
    s_cbranch_vccz LH_39
    s_sub_u32 s11, s11, 1
    s_cbranch_scc0 LH_37
LH_39:
    s_mov_b32 s10, s35
    s_add_u32 s10, s10, 163840
    buffer_load_dwordx4 v[48:51], v26, s[44:47], s10 offen offset:0 sc1
    buffer_load_dwordx4 v[52:55], v26, s[44:47], s10 offen offset:1024 sc1
    buffer_load_dwordx4 v[56:59], v26, s[44:47], s10 offen offset:2048 sc1
    buffer_load_dwordx4 v[60:63], v26, s[44:47], s10 offen offset:3072 sc1
    s_add_u32 s10, s10, 163840
    buffer_load_dwordx4 v[64:67], v26, s[44:47], s10 offen offset:0 sc1
    buffer_load_dwordx4 v[68:71], v26, s[44:47], s10 offen offset:1024 sc1
    buffer_load_dwordx4 v[72:75], v26, s[44:47], s10 offen offset:2048 sc1
    buffer_load_dwordx4 v[76:79], v26, s[44:47], s10 offen offset:3072 sc1
    s_branch LH_38
LH_40:
    s_mov_b32 s11, 0x2000
    s_mov_b32 s92, s41
    s_waitcnt vmcnt(0)
LH_41:
    s_sleep 4
    s_cmp_lt_u32 s11, 0x1ff4
    s_cselect_b32 s10, 163840, 0
    s_add_u32 s92, s92, s10
    s_cmp_ge_u32 s92, 163840
    s_cselect_b32 s92, 0, s92
    s_sub_u32 s93, s35, s41
    s_add_u32 s93, s93, s92
    buffer_load_dwordx4 v[48:51], v26, s[44:47], s93 offen offset:0 sc1
    buffer_load_dwordx4 v[52:55], v26, s[44:47], s93 offen offset:1024 sc1
    buffer_load_dwordx4 v[56:59], v26, s[44:47], s93 offen offset:2048 sc1
    buffer_load_dwordx4 v[60:63], v26, s[44:47], s93 offen offset:3072 sc1
    s_sub_u32 s10, s93, 163840
    buffer_load_dwordx4 v[6:9], v28, s[44:47], s10 offen sc1
    s_waitcnt vmcnt(0)
    v_add3_u32 v10, v48, v49, s9
    v_add3_u32 v11, v56, v57, s9
    v_add3_u32 v10, v50, v51, v10
    v_add3_u32 v11, v58, v59, v11
    v_add3_u32 v10, v52, v53, v10
    v_add3_u32 v11, v60, v61, v11
    v_add3_u32 v10, v54, v55, v10
    v_add3_u32 v11, v62, v63, v11
    s_nop 1
    v_permlane16_swap_b32 v10, v11
    v_add_u32 v10, v10, v11
    v_cmp_ne_u32 vcc, v10, v7
    s_nop 0
    s_cbranch_vccz LH_43
    s_sub_u32 s11, s11, 1
    s_cbranch_scc0 LH_41
LH_43:
    s_mov_b32 s10, s35
    s_add_u32 s10, s10, 163840
    buffer_load_dwordx4 v[64:67], v26, s[44:47], s10 offen offset:0 sc1
    buffer_load_dwordx4 v[68:71], v26, s[44:47], s10 offen offset:1024 sc1
    buffer_load_dwordx4 v[72:75], v26, s[44:47], s10 offen offset:2048 sc1
    buffer_load_dwordx4 v[76:79], v26, s[44:47], s10 offen offset:3072 sc1
    s_add_u32 s10, s10, 163840
    buffer_load_dwordx4 v[80:83], v26, s[44:47], s10 offen offset:0 sc1
    buffer_load_dwordx4 v[84:87], v26, s[44:47], s10 offen offset:1024 sc1
    buffer_load_dwordx4 v[88:91], v26, s[44:47], s10 offen offset:2048 sc1
    buffer_load_dwordx4 v[92:95], v26, s[44:47], s10 offen offset:3072 sc1
    buffer_load_dwordx4 v[176:179], v28, s[44:47], s10 offen sc1
    s_branch LH_42
LH_44:
    s_mov_b32 s11, 0x2000
    s_mov_b32 s92, s41
    s_waitcnt vmcnt(0)
LH_45:
    s_sleep 4
    s_cmp_lt_u32 s11, 0x1ff4
    s_cselect_b32 s10, 163840, 0
    s_add_u32 s92, s92, s10
    s_cmp_ge_u32 s92, 163840
    s_cselect_b32 s92, 0, s92
    s_sub_u32 s93, s35, s41
    s_add_u32 s93, s93, s92
    buffer_load_dwordx4 v[64:67], v26, s[44:47], s93 offen offset:0 sc1
    buffer_load_dwordx4 v[68:71], v26, s[44:47], s93 offen offset:1024 sc1
    buffer_load_dwordx4 v[72:75], v26, s[44:47], s93 offen offset:2048 sc1
    buffer_load_dwordx4 v[76:79], v26, s[44:47], s93 offen offset:3072 sc1
    s_sub_u32 s10, s93, 327680
    buffer_load_dwordx4 v[6:9], v28, s[44:47], s10 offen sc1
    s_waitcnt vmcnt(0)
    v_add3_u32 v10, v64, v65, s9
    v_add3_u32 v11, v72, v73, s9
    v_add3_u32 v10, v66, v67, v10
    v_add3_u32 v11, v74, v75, v11
    v_add3_u32 v10, v68, v69, v10
    v_add3_u32 v11, v76, v77, v11
    v_add3_u32 v10, v70, v71, v10
    v_add3_u32 v11, v78, v79, v11
    s_nop 1
    v_permlane16_swap_b32 v10, v11
    v_add_u32 v10, v10, v11
    v_cmp_ne_u32 vcc, v10, v8
    s_nop 0
    s_cbranch_vccz LH_47
    s_sub_u32 s11, s11, 1
    s_cbranch_scc0 LH_45
LH_47:
    s_mov_b32 s10, s35
    s_add_u32 s10, s10, 163840
    buffer_load_dwordx4 v[80:83], v26, s[44:47], s10 offen offset:0 sc1
    buffer_load_dwordx4 v[84:87], v26, s[44:47], s10 offen offset:1024 sc1
    buffer_load_dwordx4 v[88:91], v26, s[44:47], s10 offen offset:2048 sc1
    buffer_load_dwordx4 v[92:95], v26, s[44:47], s10 offen offset:3072 sc1
    buffer_load_dwordx4 v[176:179], v28, s[44:47], s10 offen sc1
    s_add_u32 s10, s10, 163840
    buffer_load_dwordx4 v[96:99], v26, s[44:47], s10 offen offset:0 sc1
    buffer_load_dwordx4 v[100:103], v26, s[44:47], s10 offen offset:1024 sc1
    buffer_load_dwordx4 v[104:107], v26, s[44:47], s10 offen offset:2048 sc1
    buffer_load_dwordx4 v[108:111], v26, s[44:47], s10 offen offset:3072 sc1
    s_branch LH_46
LH_48:
    s_mov_b32 s11, 0x2000
    s_mov_b32 s92, s41
    s_waitcnt vmcnt(0)
LH_49:
    s_sleep 4
    s_cmp_lt_u32 s11, 0x1ff4
    s_cselect_b32 s10, 163840, 0
    s_add_u32 s92, s92, s10
    s_cmp_ge_u32 s92, 163840
    s_cselect_b32 s92, 0, s92
    s_sub_u32 s93, s35, s41
    s_add_u32 s93, s93, s92
    buffer_load_dwordx4 v[80:83], v26, s[44:47], s93 offen offset:0 sc1
    buffer_load_dwordx4 v[84:87], v26, s[44:47], s93 offen offset:1024 sc1
    buffer_load_dwordx4 v[88:91], v26, s[44:47], s93 offen offset:2048 sc1
    buffer_load_dwordx4 v[92:95], v26, s[44:47], s93 offen offset:3072 sc1
    s_sub_u32 s10, s93, 0
    buffer_load_dwordx4 v[176:179], v28, s[44:47], s10 offen sc1
    s_waitcnt vmcnt(0)
    v_add3_u32 v10, v80, v81, s9
    v_add3_u32 v11, v88, v89, s9
    v_add3_u32 v10, v82, v83, v10
    v_add3_u32 v11, v90, v91, v11
    v_add3_u32 v10, v84, v85, v10
    v_add3_u32 v11, v92, v93, v11
    v_add3_u32 v10, v86, v87, v10
    v_add3_u32 v11, v94, v95, v11
    s_nop 1
    v_permlane16_swap_b32 v10, v11
    v_add_u32 v10, v10, v11
    v_cmp_ne_u32 vcc, v10, v176
    s_nop 0
    s_cbranch_vccz LH_51
    s_sub_u32 s11, s11, 1
    s_cbranch_scc0 LH_49
LH_51:
    s_mov_b32 s10, s35
    s_add_u32 s10, s10, 163840
    buffer_load_dwordx4 v[96:99], v26, s[44:47], s10 offen offset:0 sc1
    buffer_load_dwordx4 v[100:103], v26, s[44:47], s10 offen offset:1024 sc1
    buffer_load_dwordx4 v[104:107], v26, s[44:47], s10 offen offset:2048 sc1
    buffer_load_dwordx4 v[108:111], v26, s[44:47], s10 offen offset:3072 sc1
    s_add_u32 s10, s10, 163840
    buffer_load_dwordx4 v[48:51], v26, s[44:47], s10 offen offset:0 sc1
    buffer_load_dwordx4 v[52:55], v26, s[44:47], s10 offen offset:1024 sc1
    buffer_load_dwordx4 v[56:59], v26, s[44:47], s10 offen offset:2048 sc1
    buffer_load_dwordx4 v[60:63], v26, s[44:47], s10 offen offset:3072 sc1
    s_branch LH_50
LH_52:
    s_mov_b32 s11, 0x2000
    s_mov_b32 s92, s41
    s_waitcnt vmcnt(0)
LH_53:
    s_sleep 4
    s_cmp_lt_u32 s11, 0x1ff4
    s_cselect_b32 s10, 163840, 0
    s_add_u32 s92, s92, s10
    s_cmp_ge_u32 s92, 163840
    s_cselect_b32 s92, 0, s92
    s_sub_u32 s93, s35, s41
    s_add_u32 s93, s93, s92
    buffer_load_dwordx4 v[96:99], v26, s[44:47], s93 offen offset:0 sc1
    buffer_load_dwordx4 v[100:103], v26, s[44:47], s93 offen offset:1024 sc1
    buffer_load_dwordx4 v[104:107], v26, s[44:47], s93 offen offset:2048 sc1
    buffer_load_dwordx4 v[108:111], v26, s[44:47], s93 offen offset:3072 sc1
    s_sub_u32 s10, s93, 163840
    buffer_load_dwordx4 v[176:179], v28, s[44:47], s10 offen sc1
    s_waitcnt vmcnt(0)
    v_add3_u32 v10, v96, v97, s9
    v_add3_u32 v11, v104, v105, s9
    v_add3_u32 v10, v98, v99, v10
    v_add3_u32 v11, v106, v107, v11
    v_add3_u32 v10, v100, v101, v10
    v_add3_u32 v11, v108, v109, v11
    v_add3_u32 v10, v102, v103, v10
    v_add3_u32 v11, v110, v111, v11
    s_nop 1
    v_permlane16_swap_b32 v10, v11
    v_add_u32 v10, v10, v11
    v_cmp_ne_u32 vcc, v10, v177
    s_nop 0
    s_cbranch_vccz LH_55
    s_sub_u32 s11, s11, 1
    s_cbranch_scc0 LH_53
LH_55:
    s_mov_b32 s10, s35
    s_add_u32 s10, s10, 163840
    buffer_load_dwordx4 v[48:51], v26, s[44:47], s10 offen offset:0 sc1
    buffer_load_dwordx4 v[52:55], v26, s[44:47], s10 offen offset:1024 sc1
    buffer_load_dwordx4 v[56:59], v26, s[44:47], s10 offen offset:2048 sc1
    buffer_load_dwordx4 v[60:63], v26, s[44:47], s10 offen offset:3072 sc1
    s_add_u32 s10, s10, 163840
    buffer_load_dwordx4 v[64:67], v26, s[44:47], s10 offen offset:0 sc1
    buffer_load_dwordx4 v[68:71], v26, s[44:47], s10 offen offset:1024 sc1
    buffer_load_dwordx4 v[72:75], v26, s[44:47], s10 offen offset:2048 sc1
    buffer_load_dwordx4 v[76:79], v26, s[44:47], s10 offen offset:3072 sc1
    buffer_load_dwordx4 v[180:183], v28, s[44:47], s10 offen sc1
    s_branch LH_54
LH_56:
    s_mov_b32 s11, 0x2000
    s_mov_b32 s92, s41
    s_waitcnt vmcnt(0)
LH_57:
    s_sleep 4
    s_cmp_lt_u32 s11, 0x1ff4
    s_cselect_b32 s10, 163840, 0
    s_add_u32 s92, s92, s10
    s_cmp_ge_u32 s92, 163840
    s_cselect_b32 s92, 0, s92
    s_sub_u32 s93, s35, s41
    s_add_u32 s93, s93, s92
    buffer_load_dwordx4 v[48:51], v26, s[44:47], s93 offen offset:0 sc1
    buffer_load_dwordx4 v[52:55], v26, s[44:47], s93 offen offset:1024 sc1
    buffer_load_dwordx4 v[56:59], v26, s[44:47], s93 offen offset:2048 sc1
    buffer_load_dwordx4 v[60:63], v26, s[44:47], s93 offen offset:3072 sc1
    s_sub_u32 s10, s93, 327680
    buffer_load_dwordx4 v[176:179], v28, s[44:47], s10 offen sc1
    s_waitcnt vmcnt(0)
    v_add3_u32 v10, v48, v49, s9
    v_add3_u32 v11, v56, v57, s9
    v_add3_u32 v10, v50, v51, v10
    v_add3_u32 v11, v58, v59, v11
    v_add3_u32 v10, v52, v53, v10
    v_add3_u32 v11, v60, v61, v11
    v_add3_u32 v10, v54, v55, v10
    v_add3_u32 v11, v62, v63, v11
    s_nop 1
    v_permlane16_swap_b32 v10, v11
    v_add_u32 v10, v10, v11
    v_cmp_ne_u32 vcc, v10, v178
    s_nop 0
    s_cbranch_vccz LH_59
    s_sub_u32 s11, s11, 1
    s_cbranch_scc0 LH_57
LH_59:
    s_mov_b32 s10, s35
    s_add_u32 s10, s10, 163840
    buffer_load_dwordx4 v[64:67], v26, s[44:47], s10 offen offset:0 sc1
    buffer_load_dwordx4 v[68:71], v26, s[44:47], s10 offen offset:1024 sc1
    buffer_load_dwordx4 v[72:75], v26, s[44:47], s10 offen offset:2048 sc1
    buffer_load_dwordx4 v[76:79], v26, s[44:47], s10 offen offset:3072 sc1
    buffer_load_dwordx4 v[180:183], v28, s[44:47], s10 offen sc1
    s_add_u32 s10, s10, 163840
    buffer_load_dwordx4 v[80:83], v26, s[44:47], s10 offen offset:0 sc1
    buffer_load_dwordx4 v[84:87], v26, s[44:47], s10 offen offset:1024 sc1
    buffer_load_dwordx4 v[88:91], v26, s[44:47], s10 offen offset:2048 sc1
    buffer_load_dwordx4 v[92:95], v26, s[44:47], s10 offen offset:3072 sc1
    s_branch LH_58
LH_60:
    s_mov_b32 s11, 0x2000
    s_mov_b32 s92, s41
    s_waitcnt vmcnt(0)
LH_61:
    s_sleep 4
    s_cmp_lt_u32 s11, 0x1ff4
    s_cselect_b32 s10, 163840, 0
    s_add_u32 s92, s92, s10
    s_cmp_ge_u32 s92, 163840
    s_cselect_b32 s92, 0, s92
    s_sub_u32 s93, s35, s41
    s_add_u32 s93, s93, s92
    buffer_load_dwordx4 v[64:67], v26, s[44:47], s93 offen offset:0 sc1
    buffer_load_dwordx4 v[68:71], v26, s[44:47], s93 offen offset:1024 sc1
    buffer_load_dwordx4 v[72:75], v26, s[44:47], s93 offen offset:2048 sc1
    buffer_load_dwordx4 v[76:79], v26, s[44:47], s93 offen offset:3072 sc1
    s_sub_u32 s10, s93, 0
    buffer_load_dwordx4 v[180:183], v28, s[44:47], s10 offen sc1
    s_waitcnt vmcnt(0)
    v_add3_u32 v10, v64, v65, s9
    v_add3_u32 v11, v72, v73, s9
    v_add3_u32 v10, v66, v67, v10
    v_add3_u32 v11, v74, v75, v11
    v_add3_u32 v10, v68, v69, v10
    v_add3_u32 v11, v76, v77, v11
    v_add3_u32 v10, v70, v71, v10
    v_add3_u32 v11, v78, v79, v11
    s_nop 1
    v_permlane16_swap_b32 v10, v11
    v_add_u32 v10, v10, v11
    v_cmp_ne_u32 vcc, v10, v180
    s_nop 0
    s_cbranch_vccz LH_63
    s_sub_u32 s11, s11, 1
    s_cbranch_scc0 LH_61
LH_63:
    s_mov_b32 s10, s35
    s_add_u32 s10, s10, 163840
    buffer_load_dwordx4 v[80:83], v26, s[44:47], s10 offen offset:0 sc1
    buffer_load_dwordx4 v[84:87], v26, s[44:47], s10 offen offset:1024 sc1
    buffer_load_dwordx4 v[88:91], v26, s[44:47], s10 offen offset:2048 sc1
    buffer_load_dwordx4 v[92:95], v26, s[44:47], s10 offen offset:3072 sc1
    s_branch LH_62
LH_64:
    s_mov_b32 s11, 0x2000
    s_mov_b32 s92, s41
    s_waitcnt vmcnt(0)
LH_65:
    s_sleep 4
    s_cmp_lt_u32 s11, 0x1ff4
    s_cselect_b32 s10, 163840, 0
    s_add_u32 s92, s92, s10
    s_cmp_ge_u32 s92, 163840
    s_cselect_b32 s92, 0, s92
    s_sub_u32 s93, s35, s41
    s_add_u32 s93, s93, s92
    buffer_load_dwordx4 v[80:83], v26, s[44:47], s93 offen offset:0 sc1
    buffer_load_dwordx4 v[84:87], v26, s[44:47], s93 offen offset:1024 sc1
    buffer_load_dwordx4 v[88:91], v26, s[44:47], s93 offen offset:2048 sc1
    buffer_load_dwordx4 v[92:95], v26, s[44:47], s93 offen offset:3072 sc1
    s_sub_u32 s10, s93, 163840
    buffer_load_dwordx4 v[180:183], v28, s[44:47], s10 offen sc1
    s_waitcnt vmcnt(0)
    v_add3_u32 v10, v80, v81, s9
    v_add3_u32 v11, v88, v89, s9
    v_add3_u32 v10, v82, v83, v10
    v_add3_u32 v11, v90, v91, v11
    v_add3_u32 v10, v84, v85, v10
    v_add3_u32 v11, v92, v93, v11
    v_add3_u32 v10, v86, v87, v10
    v_add3_u32 v11, v94, v95, v11
    s_nop 1
    v_permlane16_swap_b32 v10, v11
    v_add_u32 v10, v10, v11
    v_cmp_ne_u32 vcc, v10, v181
    s_nop 0
    s_cbranch_vccz LH_67
    s_sub_u32 s11, s11, 1
    s_cbranch_scc0 LH_65
LH_67:
    s_mov_b32 s10, s35
    s_branch LH_66
LW_68:
    ds_read_b32 v1, v29 offset:0
    s_waitcnt lgkmcnt(0)
    v_readfirstlane_b32 s10, v1
    s_nop 0
    s_cmp_ge_u32 s10, 4
    s_cbranch_scc0 LW_68
    s_branch LW_69
LY_70:
    s_mov_b32 s11, 0x2000
LY_71:
    s_sleep 2
    buffer_load_dwordx4 v[232:235], v17, s[44:47], s34 offen sc1
    buffer_load_dwordx4 v[236:239], v17, s[44:47], s33 offen sc1
    buffer_load_dword v22, v21, s[44:47], s31 offen sc1
    buffer_load_dword v23, v21, s[44:47], s32 offen sc1
    s_waitcnt vmcnt(0)
    v_add3_u32 v10, v232, v233, s9
    v_add3_u32 v10, v234, v235, v10
    v_xor_b32 v10, v10, v22
    v_add3_u32 v11, v236, v237, s9
    v_add3_u32 v11, v238, v239, v11
    v_xor_b32 v11, v11, v23
    v_or_b32 v10, v10, v11
    v_cmp_ne_u32 vcc, 0, v10
    s_nop 0
    s_cbranch_vccz LY_72
    s_sub_u32 s11, s11, 1
    s_cbranch_scc0 LY_71
    s_branch LY_72
LW_73:
    s_sleep 2
    ds_read_b32 v24, v238 offset:224
    s_waitcnt lgkmcnt(0)
    v_readfirstlane_b32 s10, v24
    s_nop 0
    s_cmp_ge_u32 s10, 1
    s_cbranch_scc0 LW_73
    s_branch LW_74
LW_75:
    s_sleep 1
    ds_read_b32 v24, v30 offset:0
    s_waitcnt lgkmcnt(0)
    v_readfirstlane_b32 s10, v24
    s_nop 0
    s_cmp_ge_u32 s10, 4
    s_cbranch_scc0 LW_75
    s_branch LW_76
LP_77:
    s_mov_b32 s11, 0x8000
LP_78:
    s_sleep 3
    buffer_load_dword v52, v241, s[44:47], s60 offen sc1
    s_waitcnt vmcnt(0)
    v_cmp_ne_u32 vcc, s9, v52
    s_nop 0
    s_cbranch_vccz LP_79
    s_sub_u32 s11, s11, 1
    s_cbranch_scc0 LP_78
    s_branch LP_79
LW_80:
    s_sleep 1
    ds_read_b32 v24, v30 offset:0
    s_waitcnt lgkmcnt(0)
    v_readfirstlane_b32 s10, v24
    s_nop 0
    s_cmp_ge_u32 s10, 4
    s_cbranch_scc0 LW_80
    s_branch LW_81
LP_82:
    s_mov_b32 s11, 0x8000
LP_83:
    s_sleep 3
    buffer_load_dword v52, v241, s[44:47], s60 offen sc1
    s_waitcnt vmcnt(0)
    v_cmp_ne_u32 vcc, s9, v52
    s_nop 0
    s_cbranch_vccz LP_84
    s_sub_u32 s11, s11, 1
    s_cbranch_scc0 LP_83
    s_branch LP_84
LW_85:
    ds_read_b32 v24, v30 offset:0
    s_waitcnt lgkmcnt(0)
    v_readfirstlane_b32 s10, v24
    s_nop 0
    s_cmp_ge_u32 s10, 8
    s_cbranch_scc0 LW_85
    s_branch LW_86
LW_87:
    ds_read_b32 v24, v30 offset:0
    s_waitcnt lgkmcnt(0)
    v_readfirstlane_b32 s10, v24
    s_nop 0
    s_cmp_ge_u32 s10, 12
    s_cbranch_scc0 LW_87
    s_branch LW_88
LW_89:
    s_sleep 2
    ds_read_b32 v24, v238 offset:0
    s_waitcnt lgkmcnt(0)
    v_readfirstlane_b32 s10, v24
    s_nop 0
    s_cmp_ge_u32 s10, 1
    s_cbranch_scc0 LW_89
    s_branch LW_90
LW_91:
    ds_read_b32 v24, v30 offset:0
    s_waitcnt lgkmcnt(0)
    v_readfirstlane_b32 s10, v24
    s_nop 0
    s_cmp_ge_u32 s10, 16
    s_cbranch_scc0 LW_91
    s_branch LW_92
LW_93:
    ds_read_b32 v24, v30 offset:0
    s_waitcnt lgkmcnt(0)
    v_readfirstlane_b32 s10, v24
    s_nop 0
    s_cmp_ge_u32 s10, 20
    s_cbranch_scc0 LW_93
    s_branch LW_94
L_end:
    s_endpgm
.section .rodata,"a"
.p2align 6
.amdhsa_kernel parallel_sum__ssm_conv_s4__dense_activation_silu__prompt_kernel
  .amdhsa_next_free_vgpr 256
  .amdhsa_next_free_sgpr 102
  .amdhsa_accum_offset 256
  .amdhsa_group_segment_fixed_size 0
  .amdhsa_kernarg_size 120
  .amdhsa_user_sgpr_count 2
  .amdhsa_user_sgpr_kernarg_segment_ptr 1
  .amdhsa_system_sgpr_workgroup_id_x 1
.end_amdhsa_kernel
```
